```python
import torch

def _softmax(x, axis=-1):
    return torch.softmax(x, dim=axis)
def _gelu(x):
    return torch.nn.functional.gelu(x, approximate="tanh")
def _silu(x):
    return torch.nn.functional.silu(x)
def _sigmoid(x):
    return torch.sigmoid(x)
def _layernorm(x, axis=-1, eps=1e-5):
    m = x.mean(dim=axis, keepdim=True)
    v = x.var(dim=axis, keepdim=True, unbiased=False)
    return (x - m) / torch.sqrt(v + eps)
def _scatter_add(tgt, idx, src, axis=0):
    return tgt.clone().index_add_(axis, idx, src)
def _segment_sum(src, seg, n):
    out = torch.zeros((n,) + src.shape[1:], dtype=src.dtype)
    return out.index_add_(0, seg, src)
def _pad(x, pw):
    flat = tuple(v for pair in reversed(pw) for v in pair)
    return torch.nn.functional.pad(x, flat)

kernel_name = 'standalone__molecular_angular_gemnet__graph'

def setup_inputs():

    _w = (lambda a: (lambda t: t.to(torch.bfloat16) if t.is_floating_point() else t)(torch.as_tensor(a)))
    N, deg, De, L = 10000, 16, 4, 3
    E = N * deg
    T = E * deg
    NR = 8
    dist = torch.rand(E).to(float)
    angle = (torch.rand(T) * torch.pi).to(float)
    centers = torch.linspace(0.0, 1.0, NR).to(float)
    ang_freq = torch.arange(1, L + 1).to(float)
    return {
        "m": _w((lambda *s: torch.randn(*s, dtype=torch.bfloat16) * 0.05)(E, De)),
        "idx_in": _w((lambda lo, hi, *s: torch.randint(lo, hi, s))(0, E, T).to(torch.int64)),
        "idx_out": _w((lambda lo, hi, *s: torch.randint(lo, hi, s))(0, E, T).to(torch.int64)),
        "dist": _w(dist),
        "angle": _w(angle),
        "centers": _w(centers),
        "ang_freq": _w(ang_freq),
        "w_rbf": _w((lambda *s: torch.randn(*s, dtype=torch.bfloat16) * 0.2)(NR, De)),
        "w_sbf": _w((lambda *s: torch.randn(*s, dtype=torch.bfloat16) * 0.2)(NR * L, De)),
        "w_down": _w((lambda *s: torch.randn(*s, dtype=torch.bfloat16) * 0.2)(De, De)),
        "w_up": _w((lambda *s: torch.randn(*s, dtype=torch.bfloat16) * 0.2)(De, De)),
    }

def reference(m, idx_in, idx_out, dist, angle, centers, ang_freq, w_rbf, w_sbf, w_down, w_up):
    E, De = m.shape[0], m.shape[1]
    NR = centers.shape[0]
    L = ang_freq.shape[0]
    rbf = torch.exp(-10.0 * (dist[:, None] - centers[None, :]) ** 2)
    cbf = torch.cos(ang_freq[None, :] * angle[:, None])
    rbf_t = rbf[idx_out]
    sbf = torch.reshape(rbf_t[:, :, None] * cbf[:, None, :], (-1, NR * L))
    x = (m[idx_in] @ w_down) * (sbf @ w_sbf)
    agg = _segment_sum(x, idx_out, E)
    return m + (agg @ w_up) * (rbf @ w_rbf)
```

```asm
; @launch kernel=bin_kernel grid=(256,1,1) block=(1024,1,1) lds=68096
; @launch kernel=acc_kernel grid=(256,1,1) block=(1024,1,1) lds=155968
.amdgcn_target "amdgcn-amd-amdhsa--gfx950"
.text
.globl bin_kernel
.p2align 8
.type bin_kernel,@function
bin_kernel:
s_cmp_ge_u32 s2, 256
s_cbranch_scc1 bin_end
s_load_dwordx4 s[4:7], s[0:1], 0
s_load_dwordx2 s[8:9], s[0:1], 16
s_load_dwordx2 s[10:11], s[0:1], 32
s_load_dwordx2 s[12:13], s[0:1], 72
s_load_dwordx2 s[14:15], s[0:1], 104
s_load_dwordx4 s[92:95], s[0:1], 40
s_load_dwordx4 s[96:99], s[0:1], 56
s_load_dwordx2 s[84:85], s[0:1], 80
v_lshlrev_b32 v1, 4, v0
v_lshlrev_b32 v2, 3, v0
v_lshlrev_b32 v3, 2, v0
v_lshrrev_b32 v5, 6, v0
s_mul_i32 s76, s2, 40000
s_add_u32 s77, s76, 16384
s_mul_i32 s78, s2, 20000
s_add_u32 s79, s78, 8192
v_readfirstlane_b32 s80, v5
s_add_u32 s88, s76, 32768
v_add_u32 v6, s88, v2
s_add_u32 s88, s78, 16384
v_add_u32 v7, s88, v3
s_mov_b32 s19, 0x20000
s_mov_b32 s23, 0x20000
s_mov_b32 s27, 0x20000
s_mov_b32 s18, 10240000
s_mov_b32 s22, 10240000
s_mov_b32 s26, 5120000
v_and_b32 v4, 63, v0
v_mov_b32 v71, 0
v_lshlrev_b32 v72, 2, v4
s_cmp_lt_u32 s80, 4
s_cbranch_scc0 bin_init1
ds_write_b32 v3, v71 offset:0
bin_init1:
s_cmp_eq_u32 s80, 4
s_cbranch_scc0 bin_init2
ds_write_b32 v72, v71 offset:2048
bin_init2:
s_or_b32 s89, s2, s80
s_mov_b32 s72, 6871948
s_mov_b32 s73, -625
s_mov_b32 s75, 0xffff0000
v_mov_b32 v31, 6
s_waitcnt lgkmcnt(0)
s_mov_b32 s16, s8
s_and_b32 s17, s9, 0xffff
s_mov_b32 s20, s6
s_and_b32 s21, s7, 0xffff
s_mov_b32 s24, s10
s_and_b32 s25, s11, 0xffff
buffer_load_dwordx4 v[8:11], v1, s[16:19], s76 offen
buffer_load_dwordx4 v[12:15], v1, s[16:19], s77 offen
buffer_load_dwordx2 v[16:17], v6, s[16:19], 0 offen
s_load_dwordx8 s[48:55], s[12:13], 0
s_barrier
s_add_u32 s36, s14, 22020096
s_addc_u32 s37, s15, 0
s_and_b32 s37, s37, 0xffff
s_mov_b32 s38, 1280000
s_mov_b32 s39, 0x20000
s_add_u32 s40, s14, 20971520
s_addc_u32 s41, s15, 0
s_and_b32 s41, s41, 0xffff
s_mov_b32 s42, 262144
s_mov_b32 s43, 0x20000
s_add_u32 s44, s14, 24117248
s_addc_u32 s45, s15, 0
s_and_b32 s45, s45, 0xffff
s_mov_b32 s46, 1024
s_mov_b32 s47, 0x20000
s_mul_i32 s88, s2, 61568
s_add_u32 s32, s14, s88
s_addc_u32 s33, s15, 0
s_and_b32 s33, s33, 0xffff
s_mov_b32 s34, 61568
s_mov_b32 s35, 0x20000
s_waitcnt vmcnt(2) lgkmcnt(0)
v_mul_hi_u32_u24 v74, s72, v8
v_mad_i32_i24 v40, v74, s73, v8
v_lshlrev_b32 v8, 2, v74
ds_add_rtn_u32 v60, v8, v31 offset:0
v_mul_hi_u32_u24 v75, s72, v9
v_mad_i32_i24 v41, v75, s73, v9
v_lshlrev_b32 v9, 2, v75
ds_add_rtn_u32 v61, v9, v31 offset:0
v_mul_hi_u32_u24 v76, s72, v10
v_mad_i32_i24 v42, v76, s73, v10
v_lshlrev_b32 v10, 2, v76
ds_add_rtn_u32 v62, v10, v31 offset:0
v_mul_hi_u32_u24 v77, s72, v11
v_mad_i32_i24 v43, v77, s73, v11
v_lshlrev_b32 v11, 2, v77
ds_add_rtn_u32 v63, v11, v31 offset:0
s_waitcnt vmcnt(1)
v_mul_hi_u32_u24 v74, s72, v12
v_mad_i32_i24 v44, v74, s73, v12
v_lshlrev_b32 v12, 2, v74
ds_add_rtn_u32 v64, v12, v31 offset:0
v_mul_hi_u32_u24 v75, s72, v13
v_mad_i32_i24 v45, v75, s73, v13
v_lshlrev_b32 v13, 2, v75
ds_add_rtn_u32 v65, v13, v31 offset:0
v_mul_hi_u32_u24 v76, s72, v14
v_mad_i32_i24 v46, v76, s73, v14
v_lshlrev_b32 v14, 2, v76
ds_add_rtn_u32 v66, v14, v31 offset:0
v_mul_hi_u32_u24 v77, s72, v15
v_mad_i32_i24 v47, v77, s73, v15
v_lshlrev_b32 v15, 2, v77
ds_add_rtn_u32 v67, v15, v31 offset:0
s_waitcnt vmcnt(0)
v_cmp_gt_u32 vcc, 904, v0
s_and_saveexec_b64 s[82:83], vcc
s_cbranch_execz bin_ra
v_mul_hi_u32_u24 v74, s72, v16
v_mad_i32_i24 v48, v74, s73, v16
v_lshlrev_b32 v16, 2, v74
ds_add_rtn_u32 v68, v16, v31 offset:0
v_mul_hi_u32_u24 v75, s72, v17
v_mad_i32_i24 v49, v75, s73, v17
v_lshlrev_b32 v17, 2, v75
ds_add_rtn_u32 v69, v17, v31 offset:0
bin_ra:
s_mov_b64 exec, s[82:83]
s_cmp_lt_u32 s80, 4
s_cbranch_scc0 bin_rest_a_done
buffer_load_dwordx4 v[20:23], v1, s[20:23], s76 offen
buffer_load_dwordx2 v[32:33], v2, s[24:27], s78 offen
buffer_load_dwordx4 v[24:27], v1, s[20:23], s77 offen
buffer_load_dwordx2 v[34:35], v2, s[24:27], s79 offen
buffer_load_dwordx2 v[28:29], v6, s[20:23], 0 offen
buffer_load_dword v36, v7, s[24:27], 0 offen
s_mov_b32 s28, s4
s_and_b32 s29, s5, 0xffff
s_mov_b32 s30, 1280000
s_mov_b32 s31, 0x20000
s_mul_i32 s88, s2, 5000
v_add_u32 v37, s88, v2
s_cmp_lt_u32 s80, 10
s_cbranch_scc0 bin_nom_a
buffer_load_dwordx2 v[38:39], v37, s[28:31], 0 offen
bin_nom_a:
s_cmp_eq_u32 s89, 0
s_cbranch_scc0 bin_pl_done_a
v_and_b32 v100, 31, v4
v_lshrrev_b32 v101, 5, v4
v_mov_b32 v116, 0
v_mov_b32 v117, 0
v_mov_b32 v118, 0
v_mov_b32 v119, 0
v_mov_b32 v120, 0
v_mul_u32_u24 v102, 96, v101
v_lshl_add_u32 v102, v100, 1, v102
v_and_b32 v103, 3, v4
v_lshlrev_b32 v103, 1, v103
v_lshl_add_u32 v103, v101, 5, v103
v_lshlrev_b32 v121, 1, v4
v_subrev_u32 v122, 32, v121
v_subrev_u32 v123, 40, v121
s_mov_b32 exec_lo, 0x00000fff
s_mov_b32 exec_hi, 0x00000fff
global_load_ushort v116, v102, s[98:99] offset:0
global_load_ushort v117, v102, s[98:99] offset:24
global_load_ushort v118, v102, s[98:99] offset:48
global_load_ushort v119, v102, s[98:99] offset:72
s_mov_b32 exec_lo, 0x0000f000
s_mov_b32 exec_hi, 0x0000f000
global_load_ushort v116, v103, s[96:97] offset:0
global_load_ushort v117, v103, s[96:97] offset:8
global_load_ushort v118, v103, s[96:97] offset:16
global_load_ushort v119, v103, s[96:97] offset:24
s_mov_b32 exec_lo, 0x0000ffff
s_mov_b32 exec_hi, 0
global_load_ushort v120, v121, s[84:85]
s_mov_b32 exec_lo, 0x00070000
global_load_ushort v120, v122, s[94:95]
s_mov_b32 exec_lo, 0x0ff00000
global_load_ushort v120, v123, s[92:93]
s_mov_b64 exec, -1
bin_pl_done_a:
bin_rest_a_done:
s_waitcnt lgkmcnt(0)
s_barrier
s_cmp_eq_u32 s80, 0
s_cbranch_scc0 bin_scan_done
v_lshlrev_b32 v70, 4, v4
ds_read_b128 v[112:115], v70 offset:0
s_waitcnt lgkmcnt(0)
v_and_b32 v72, 2, v112
v_and_b32 v73, 2, v113
v_and_b32 v74, 2, v114
v_and_b32 v75, 2, v115
v_mad_u32_u24 v112, v72, 3, v112
v_mad_u32_u24 v113, v73, 3, v113
v_mad_u32_u24 v114, v74, 3, v114
v_mad_u32_u24 v115, v75, 3, v115
v_add_u32 v72, v112, v113
v_add_u32 v73, v72, v114
v_add_u32 v74, v73, v115
v_mov_b32 v75, v74
s_nop 1
v_add_u32_dpp v75, v75, v75 row_shr:1 row_mask:0xf bank_mask:0xf bound_ctrl:0
s_nop 1
v_add_u32_dpp v75, v75, v75 row_shr:2 row_mask:0xf bank_mask:0xf bound_ctrl:0
s_nop 1
v_add_u32_dpp v75, v75, v75 row_shr:4 row_mask:0xf bank_mask:0xf bound_ctrl:0
s_nop 1
v_add_u32_dpp v75, v75, v75 row_shr:8 row_mask:0xf bank_mask:0xf bound_ctrl:0
s_nop 1
v_add_u32_dpp v75, v75, v75 row_bcast:15 row_mask:0xa bank_mask:0xf
s_nop 1
v_add_u32_dpp v75, v75, v75 row_bcast:31 row_mask:0xc bank_mask:0xf
v_sub_u32 v75, v75, v74
v_add_u32 v108, 2560, v75
v_add_u32 v109, v108, v112
v_add_u32 v110, v108, v72
v_add_u32 v111, v108, v73
ds_write_b128 v70, v[108:111] offset:1024
s_waitcnt lgkmcnt(0)
bin_scan_done:
s_barrier
s_cmp_lt_u32 s80, 4
s_cbranch_scc1 bin_rest_b_done
buffer_load_dwordx4 v[20:23], v1, s[20:23], s76 offen
buffer_load_dwordx2 v[32:33], v2, s[24:27], s78 offen
buffer_load_dwordx4 v[24:27], v1, s[20:23], s77 offen
buffer_load_dwordx2 v[34:35], v2, s[24:27], s79 offen
buffer_load_dwordx2 v[28:29], v6, s[20:23], 0 offen
buffer_load_dword v36, v7, s[24:27], 0 offen
s_mov_b32 s28, s4
s_and_b32 s29, s5, 0xffff
s_mov_b32 s30, 1280000
s_mov_b32 s31, 0x20000
s_mul_i32 s88, s2, 5000
v_add_u32 v37, s88, v2
s_cmp_lt_u32 s80, 10
s_cbranch_scc0 bin_nom_b
buffer_load_dwordx2 v[38:39], v37, s[28:31], 0 offen
bin_nom_b:
s_cmp_eq_u32 s89, 0
s_cbranch_scc0 bin_pl_done_b
v_and_b32 v100, 31, v4
v_lshrrev_b32 v101, 5, v4
v_mov_b32 v116, 0
v_mov_b32 v117, 0
v_mov_b32 v118, 0
v_mov_b32 v119, 0
v_mov_b32 v120, 0
v_mul_u32_u24 v102, 96, v101
v_lshl_add_u32 v102, v100, 1, v102
v_and_b32 v103, 3, v4
v_lshlrev_b32 v103, 1, v103
v_lshl_add_u32 v103, v101, 5, v103
v_lshlrev_b32 v121, 1, v4
v_subrev_u32 v122, 32, v121
v_subrev_u32 v123, 40, v121
s_mov_b32 exec_lo, 0x00000fff
s_mov_b32 exec_hi, 0x00000fff
global_load_ushort v116, v102, s[98:99] offset:0
global_load_ushort v117, v102, s[98:99] offset:24
global_load_ushort v118, v102, s[98:99] offset:48
global_load_ushort v119, v102, s[98:99] offset:72
s_mov_b32 exec_lo, 0x0000f000
s_mov_b32 exec_hi, 0x0000f000
global_load_ushort v116, v103, s[96:97] offset:0
global_load_ushort v117, v103, s[96:97] offset:8
global_load_ushort v118, v103, s[96:97] offset:16
global_load_ushort v119, v103, s[96:97] offset:24
s_mov_b32 exec_lo, 0x0000ffff
s_mov_b32 exec_hi, 0
global_load_ushort v120, v121, s[84:85]
s_mov_b32 exec_lo, 0x00070000
global_load_ushort v120, v122, s[94:95]
s_mov_b32 exec_lo, 0x0ff00000
global_load_ushort v120, v123, s[92:93]
s_mov_b64 exec, -1
bin_pl_done_b:
bin_rest_b_done:
ds_read_b32 v80, v8 offset:1024
ds_read_b32 v81, v9 offset:1024
ds_read_b32 v82, v10 offset:1024
ds_read_b32 v83, v11 offset:1024
ds_read_b32 v84, v12 offset:1024
ds_read_b32 v85, v13 offset:1024
ds_read_b32 v86, v14 offset:1024
ds_read_b32 v87, v15 offset:1024
v_and_b32 v70, 15, v4
s_lshl_b32 s84, s80, 4
v_add_u32 v70, s84, v70
v_lshlrev_b32 v71, 2, v70
ds_read_b32 v72, v71 offset:1024
ds_read_b32 v73, v71 offset:0
v_cmp_gt_u32 vcc, 904, v0
s_and_saveexec_b64 s[82:83], vcc
s_cbranch_execz bin_rb
ds_read_b32 v88, v16 offset:1024
ds_read_b32 v89, v17 offset:1024
s_waitcnt lgkmcnt(0)
v_add_u32 v68, v88, v68
v_add_u32 v69, v89, v69
v_and_b32 v88, 2, v68
v_and_b32 v89, 2, v69
v_sub_u32 v68, v68, v88
v_sub_u32 v69, v69, v89
v_sub_u32 v98, v68, v88
v_sub_u32 v99, v69, v89
v_lshlrev_b32 v48, 21, v48
v_lshlrev_b32 v49, 21, v49
bin_rb:
s_mov_b64 exec, s[82:83]
s_waitcnt lgkmcnt(0)
v_subrev_u32 v72, 2560, v72
v_mul_u32_u24 v73, 43691, v73
v_lshrrev_b32 v73, 18, v73
v_lshl_or_b32 v72, v73, 16, v72
v_lshlrev_b32 v71, 10, v70
s_lshl_b32 s86, s2, 2
v_add_u32 v71, s86, v71
s_mov_b32 exec_lo, 0xffff
s_mov_b32 exec_hi, 0
buffer_store_dword v72, v71, s[40:43], 0 offen
s_mov_b64 exec, -1
v_add_u32 v60, v80, v60
v_add_u32 v61, v81, v61
v_add_u32 v62, v82, v62
v_add_u32 v63, v83, v63
v_add_u32 v64, v84, v64
v_add_u32 v65, v85, v65
v_add_u32 v66, v86, v66
v_add_u32 v67, v87, v67
v_and_b32 v80, 2, v60
v_and_b32 v81, 2, v61
v_and_b32 v82, 2, v62
v_and_b32 v83, 2, v63
v_and_b32 v84, 2, v64
v_and_b32 v85, 2, v65
v_and_b32 v86, 2, v66
v_and_b32 v87, 2, v67
v_sub_u32 v60, v60, v80
v_sub_u32 v61, v61, v81
v_sub_u32 v62, v62, v82
v_sub_u32 v63, v63, v83
v_sub_u32 v64, v64, v84
v_sub_u32 v65, v65, v85
v_sub_u32 v66, v66, v86
v_sub_u32 v67, v67, v87
v_sub_u32 v90, v60, v80
v_sub_u32 v91, v61, v81
v_sub_u32 v92, v62, v82
v_sub_u32 v93, v63, v83
v_sub_u32 v94, v64, v84
v_sub_u32 v95, v65, v85
v_sub_u32 v96, v66, v86
v_sub_u32 v97, v67, v87
v_lshlrev_b32 v40, 21, v40
v_lshlrev_b32 v41, 21, v41
v_lshlrev_b32 v42, 21, v42
v_lshlrev_b32 v43, 21, v43
v_lshlrev_b32 v44, 21, v44
v_lshlrev_b32 v45, 21, v45
v_lshlrev_b32 v46, 21, v46
v_lshlrev_b32 v47, 21, v47
s_waitcnt vmcnt(5)
v_lshl_or_b32 v20, v20, 3, v40
ds_write_b32 v60, v20
ds_write_b16 v90, v32 offset:8
v_lshl_or_b32 v21, v21, 3, v41
ds_write_b32 v61, v21
ds_write_b16_d16_hi v91, v32 offset:8
v_lshl_or_b32 v22, v22, 3, v42
ds_write_b32 v62, v22
ds_write_b16 v92, v33 offset:8
v_lshl_or_b32 v23, v23, 3, v43
ds_write_b32 v63, v23
ds_write_b16_d16_hi v93, v33 offset:8
s_waitcnt vmcnt(3)
v_lshl_or_b32 v24, v24, 3, v44
ds_write_b32 v64, v24
ds_write_b16 v94, v34 offset:8
v_lshl_or_b32 v25, v25, 3, v45
ds_write_b32 v65, v25
ds_write_b16_d16_hi v95, v34 offset:8
v_lshl_or_b32 v26, v26, 3, v46
ds_write_b32 v66, v26
ds_write_b16 v96, v35 offset:8
v_lshl_or_b32 v27, v27, 3, v47
ds_write_b32 v67, v27
ds_write_b16_d16_hi v97, v35 offset:8
s_waitcnt vmcnt(1)
v_cmp_gt_u32 vcc, 904, v0
s_and_saveexec_b64 s[82:83], vcc
s_cbranch_execz bin_rc
v_lshl_or_b32 v28, v28, 3, v48
ds_write_b32 v68, v28
ds_write_b16 v98, v36 offset:8
v_lshl_or_b32 v29, v29, 3, v49
ds_write_b32 v69, v29
ds_write_b16_d16_hi v99, v36 offset:8
bin_rc:
s_mov_b64 exec, s[82:83]
s_cmp_lt_u32 s80, 10
s_cbranch_scc0 bin_md_done
s_lshl_b32 s56, s48, 16
s_and_b32 s57, s48, s75
s_lshl_b32 s58, s49, 16
s_and_b32 s59, s49, s75
s_lshl_b32 s60, s50, 16
s_and_b32 s61, s50, s75
s_lshl_b32 s62, s51, 16
s_and_b32 s63, s51, s75
s_lshl_b32 s64, s52, 16
s_and_b32 s65, s52, s75
s_lshl_b32 s66, s53, 16
s_and_b32 s67, s53, s75
s_lshl_b32 s68, s54, 16
s_and_b32 s69, s54, s75
s_lshl_b32 s70, s55, 16
s_and_b32 s71, s55, s75
v_lshlrev_b32 v70, 16, v38
v_and_b32 v71, s75, v38
v_lshlrev_b32 v72, 16, v39
v_and_b32 v73, s75, v39
v_mul_f32 v74, s56, v70
v_fmac_f32 v74, s60, v71
v_fmac_f32 v74, s64, v72
v_fmac_f32 v74, s68, v73
v_mul_f32 v75, s57, v70
v_fmac_f32 v75, s61, v71
v_fmac_f32 v75, s65, v72
v_fmac_f32 v75, s69, v73
v_mul_f32 v76, s58, v70
v_fmac_f32 v76, s62, v71
v_fmac_f32 v76, s66, v72
v_fmac_f32 v76, s70, v73
v_mul_f32 v77, s59, v70
v_fmac_f32 v77, s63, v71
v_fmac_f32 v77, s67, v72
v_fmac_f32 v77, s71, v73
v_cmp_gt_u32 vcc, 625, v0
v_cvt_pk_bf16_f32 v78, v74, v75
v_cvt_pk_bf16_f32 v79, v76, v77
v_max3_f32 v70, |v74|, |v75|, |v76|
v_max_f32 v70, |v77|, v70
v_mov_b32 v71, 0x7ffffff8
v_cndmask_b32 v71, v71, v37, vcc
v_lshlrev_b32 v72, 2, v4
v_cndmask_b32 v70, 0, v70, vcc
buffer_store_dwordx2 v[78:79], v71, s[36:39], 0 offen
ds_max_u32 v72, v70 offset:2048
bin_md_done:
s_cmp_eq_u32 s89, 0
s_cbranch_scc0 bin_pc_done
s_waitcnt vmcnt(0)
v_lshlrev_b32 v116, 16, v116
v_lshlrev_b32 v117, 16, v117
v_lshlrev_b32 v118, 16, v118
v_lshlrev_b32 v119, 16, v119
v_add_f32 v102, |v116|, |v117|
v_add_f32 v103, |v118|, |v119|
v_cmp_gt_u32 vcc, 12, v100
v_add_f32 v102, v102, v103
v_lshlrev_b32 v120, 16, v120
v_mov_b32 v121, 1.0
v_cndmask_b32 v102, 0, v102, vcc
v_mov_b32 v122, 0.15915494
s_mov_b32 s90, 0x00070000
s_mov_b32 s91, 0
v_add_f32_dpp v102, v102, v102 row_ror:4 row_mask:0xf bank_mask:0xf
v_cndmask_b32 v121, v121, v122, s[90:91]
s_nop 0
v_add_f32_dpp v102, v102, v102 row_ror:8 row_mask:0xf bank_mask:0xf
v_mul_f32 v120, v120, v121
v_mov_b32 v103, v102
s_nop 1
v_permlane32_swap_b32 v102, v103
v_mov_b32 v121, 60
v_mov_b32 v122, -60
v_add_f32 v102, v102, v103
v_mul_f32 v102, 0x3f810000, v102
v_frexp_exp_i32_f32 v102, v102
v_sub_u32 v102, 0, v102
v_med3_i32 v102, v102, v122, v121
v_lshlrev_b32 v121, 3, v4
v_cndmask_b32 v103, 0, v102, vcc
v_lshlrev_b32 v122, 2, v4
v_add_u32 v121, 24118272, v121
v_add_u32 v122, 24118784, v122
v_ldexp_f32 v116, v116, v103
v_ldexp_f32 v117, v117, v103
v_ldexp_f32 v118, v118, v103
v_ldexp_f32 v119, v119, v103
v_add_u32 v123, 112, v122
v_cvt_pk_bf16_f32 v116, v116, v117
v_cvt_pk_bf16_f32 v117, v118, v119
global_store_dwordx2 v121, v[116:117], s[14:15]
s_mov_b32 exec_lo, 0x0fffffff
s_mov_b32 exec_hi, 0
global_store_dword v122, v120, s[14:15]
s_mov_b32 exec_lo, 0xf
global_store_dword v123, v102, s[14:15]
s_mov_b64 exec, -1
bin_pc_done:
v_add_u32 v70, 2560, v1
s_mov_b32 s64, 16384
s_mov_b32 s65, 32768
v_add_u32 v72, 49152, v1
s_waitcnt lgkmcnt(0)
s_barrier
ds_read_b128 v[80:83], v70 offset:0
ds_read_b128 v[84:87], v70 offset:16384
ds_read_b128 v[88:91], v70 offset:32768
ds_read_b128 v[92:95], v70 offset:49152
s_waitcnt lgkmcnt(3)
buffer_store_dwordx4 v[80:83], v1, s[32:35], 0 offen sc1
s_waitcnt lgkmcnt(2)
buffer_store_dwordx4 v[84:87], v1, s[32:35], s64 offen sc1
s_waitcnt lgkmcnt(1)
buffer_store_dwordx4 v[88:91], v1, s[32:35], s65 offen sc1
s_waitcnt lgkmcnt(0)
buffer_store_dwordx4 v[92:95], v72, s[32:35], 0 offen sc1
s_cmp_eq_u32 s80, 4
s_cbranch_scc0 bin_max_done
v_lshlrev_b32 v74, 2, v4
ds_read_b32 v75, v74 offset:2048
s_waitcnt lgkmcnt(0)
s_nop 1
v_max_u32_dpp v75, v75, v75 row_shr:1 row_mask:0xf bank_mask:0xf bound_ctrl:0
s_nop 1
v_max_u32_dpp v75, v75, v75 row_shr:2 row_mask:0xf bank_mask:0xf bound_ctrl:0
s_nop 1
v_max_u32_dpp v75, v75, v75 row_shr:4 row_mask:0xf bank_mask:0xf bound_ctrl:0
s_nop 1
v_max_u32_dpp v75, v75, v75 row_shr:8 row_mask:0xf bank_mask:0xf bound_ctrl:0
s_nop 1
v_max_u32_dpp v75, v75, v75 row_bcast:15 row_mask:0xa bank_mask:0xf
s_nop 1
v_max_u32_dpp v75, v75, v75 row_bcast:31 row_mask:0xc bank_mask:0xf
s_lshl_b32 s88, s2, 2
v_mov_b32 v74, s88
s_mov_b32 exec_lo, 0
s_mov_b32 exec_hi, 0x80000000
buffer_store_dword v75, v74, s[44:47], 0 offen
s_mov_b64 exec, -1
bin_max_done:
bin_end:
s_endpgm
.globl acc_kernel
.p2align 8
.type acc_kernel,@function
acc_kernel:
s_cmp_ge_u32 s2, 256
s_cbranch_scc1 acc_end
s_load_dwordx2 s[20:21], s[0:1], 104
s_load_dwordx2 s[4:5], s[0:1], 0
s_load_dwordx2 s[6:7], s[0:1], 24
s_load_dwordx2 s[18:19], s[0:1], 88
v_and_b32 v1, 63, v0
v_lshrrev_b32 v6, 6, v0
v_and_b32 v16, 31, v1
v_lshrrev_b32 v17, 5, v1
s_and_b32 s3, s2, 7
s_lshl_b32 s3, s3, 5
s_lshr_b32 s22, s2, 3
s_or_b32 s3, s3, s22
v_readfirstlane_b32 s22, v6
s_lshl_b32 s38, s3, 10
s_add_u32 s38, s38, 20971520
v_lshlrev_b32 v3, 5, v17
s_lshl_b32 s37, s22, 6
v_add_u32 v3, s37, v3
v_mul_u32_u24 v2, 492544, v17
v_mul_u32_u24 v8, 12, v16
s_mul_i32 s37, s22, 985088
v_add3_u32 v2, v2, s37, v8
s_mov_b32 s26, 15761408
s_mov_b32 s27, 0x20000
s_waitcnt lgkmcnt(0)
s_add_u32 s32, s20, s38
s_addc_u32 s33, s21, 0
global_load_dwordx4 v[112:115], v3, s[32:33]
global_load_dwordx4 v[116:119], v3, s[32:33] offset:16
s_mov_b32 s24, s20
s_and_b32 s25, s21, 0xffff
s_add_u32 s34, s20, 24117248
s_addc_u32 s35, s21, 0
s_load_dwordx4 s[12:15], s[34:35], 1600
v_mov_b32 v12, 0
v_mov_b32 v13, 0
v_mov_b32 v14, 0
v_mov_b32 v15, 0
v_lshlrev_b32 v20, 3, v1
v_mov_b32 v10, 0x7ffffff8
v_mov_b32 v11, v1
s_mul_i32 s37, s22, 520
s_add_u32 s37, s37, 39488
v_add_u32 v20, s37, v20
v_add_u32 v7, 58240, v20
s_sub_u32 s37, s22, 4
s_cmp_lt_u32 s37, 10
s_cbranch_scc0 acc_noz
v_subrev_u32 v8, 256, v0
v_lshlrev_b32 v8, 4, v8
ds_write_b128 v8, v[12:15] offset:29248
v_subrev_u32 v8, 256, v0
v_lshlrev_b32 v8, 2, v8
ds_write_b32 v8, v12 offset:26688
v_mov_b32 v8, 25608
ds_write_b32 v8, v12
acc_noz:
v_cmp_gt_u32 vcc, 224, v0
s_and_saveexec_b64 s[36:37], vcc
s_cbranch_execz acc_noh
v_lshlrev_b32 v8, 2, v0
v_mul_u32_u24 v9, 520, v0
v_add_u32 v9, 39488, v9
ds_write_b32 v8, v9 offset:25664
acc_noh:
s_mov_b64 exec, -1
s_mov_b32 s30, 1280000
s_mov_b32 s31, 0x20000
s_add_u32 s28, s20, 22020096
s_addc_u32 s29, s21, 0
s_and_b32 s29, s29, 0xffff
v_lshlrev_b32 v18, 1, v16
v_add_u32 v19, 1, v18
s_mul_i32 s36, s3, 625
v_mov_b32 v21, 0xffff0000
v_mov_b32 v25, 0x4f800000
v_mov_b32 v28, 0
v_mov_b32 v29, 0
v_mov_b32 v30, 0
s_mov_b32 s10, 0
s_mov_b32 s11, 0
s_mov_b32 s23, 0
s_mov_b32 s42, 0
s_mov_b64 s[8:9], 0
s_mov_b64 s[40:41], 0
s_waitcnt lgkmcnt(0)
s_barrier
s_cmp_lt_u32 s22, 4
s_cbranch_scc0 acc_notg
v_lshlrev_b32 v8, 4, v1
v_lshlrev_b32 v9, 3, v1
v_lshlrev_b32 v10, 4, v17
global_load_dwordx4 v[84:87], v8, s[34:35]
global_load_dwordx2 v[66:67], v9, s[34:35] offset:1024
global_load_dwordx4 v[68:71], v10, s[34:35] offset:1616
s_mul_i32 s37, s22, 160
s_add_u32 s37, s37, s36
v_add_u32 v11, s37, v16
v_mov_b32 v12, 159999
v_add_u32 v13, 0, v11
v_min_u32 v13, v13, v12
v_lshlrev_b32 v13, 1, v13
global_load_ushort v120, v13, s[6:7]
v_add_u32 v13, 32, v11
v_min_u32 v13, v13, v12
v_lshlrev_b32 v13, 1, v13
global_load_ushort v121, v13, s[6:7]
v_add_u32 v13, 64, v11
v_min_u32 v13, v13, v12
v_lshlrev_b32 v13, 1, v13
global_load_ushort v122, v13, s[6:7]
v_add_u32 v13, 96, v11
v_min_u32 v13, v13, v12
v_lshlrev_b32 v13, 1, v13
global_load_ushort v123, v13, s[6:7]
v_add_u32 v13, 128, v11
v_min_u32 v13, v13, v12
v_lshlrev_b32 v13, 1, v13
global_load_ushort v124, v13, s[6:7]
v_add_u32 v14, s36, v0
v_lshlrev_b32 v14, 3, v14
global_load_dwordx2 v[4:5], v14, s[4:5]
s_load_dwordx16 s[80:95], s[34:35], 1536
s_load_dwordx4 s[44:47], s[34:35], 1648
s_waitcnt vmcnt(9)
v_max3_u32 v8, v112, v113, v114
v_max3_u32 v9, v115, v116, v117
v_max3_u32 v8, v8, v118, v119
v_max_u32 v8, v8, v9
v_cmp_lt_u32 vcc, 4128767, v8
s_cmp_eq_u64 vcc, 0
s_cbranch_scc0 acc_xsetup_g
acc_nox_g:
v_add_u32_sdwa v35, v2, v112 dst_sel:DWORD dst_unused:UNUSED_PAD src0_sel:DWORD src1_sel:WORD_0
v_add_u32_sdwa v39, v2, v113 dst_sel:DWORD dst_unused:UNUSED_PAD src0_sel:DWORD src1_sel:WORD_0
v_add_u32_sdwa v43, v2, v114 dst_sel:DWORD dst_unused:UNUSED_PAD src0_sel:DWORD src1_sel:WORD_0
v_add_u32_sdwa v47, v2, v115 dst_sel:DWORD dst_unused:UNUSED_PAD src0_sel:DWORD src1_sel:WORD_0
v_add_u32_sdwa v51, v2, v116 dst_sel:DWORD dst_unused:UNUSED_PAD src0_sel:DWORD src1_sel:WORD_0
v_add_u32_sdwa v55, v2, v117 dst_sel:DWORD dst_unused:UNUSED_PAD src0_sel:DWORD src1_sel:WORD_0
v_add_u32_sdwa v59, v2, v118 dst_sel:DWORD dst_unused:UNUSED_PAD src0_sel:DWORD src1_sel:WORD_0
v_add_u32_sdwa v63, v2, v119 dst_sel:DWORD dst_unused:UNUSED_PAD src0_sel:DWORD src1_sel:WORD_0
v_lshrrev_b32 v112, 16, v112
v_lshrrev_b32 v113, 16, v113
v_lshrrev_b32 v114, 16, v114
v_lshrrev_b32 v115, 16, v115
v_lshrrev_b32 v116, 16, v116
v_lshrrev_b32 v117, 16, v117
v_lshrrev_b32 v118, 16, v118
v_lshrrev_b32 v119, 16, v119
v_min_u32 v112, 62, v112
v_min_u32 v113, 62, v113
v_min_u32 v114, 62, v114
v_min_u32 v115, 62, v115
v_min_u32 v116, 62, v116
v_min_u32 v117, 62, v117
v_min_u32 v118, 62, v118
v_min_u32 v119, 62, v119
v_cmp_gt_u32 s[48:49], v112, v18
v_cmp_gt_u32 s[52:53], v113, v18
v_cmp_gt_u32 s[56:57], v114, v18
v_cmp_gt_u32 s[60:61], v115, v18
v_cmp_gt_u32 s[64:65], v116, v18
v_cmp_gt_u32 s[68:69], v117, v18
v_cmp_gt_u32 s[72:73], v118, v18
v_cmp_gt_u32 s[76:77], v119, v18
s_mov_b32 s36, 0
s_mov_b64 exec, s[48:49]
buffer_load_dwordx3 v[32:34], v35, s[24:27], s36 offen
s_mov_b32 s36, 61568
s_mov_b64 exec, s[52:53]
buffer_load_dwordx3 v[36:38], v39, s[24:27], s36 offen
s_mov_b32 s36, 123136
s_mov_b64 exec, s[56:57]
buffer_load_dwordx3 v[40:42], v43, s[24:27], s36 offen
s_mov_b32 s36, 184704
s_mov_b64 exec, s[60:61]
buffer_load_dwordx3 v[44:46], v47, s[24:27], s36 offen
s_mov_b64 exec, -1
v_cmp_gt_u32 s[50:51], v112, v19
v_cmp_gt_u32 s[54:55], v113, v19
v_cmp_gt_u32 s[58:59], v114, v19
v_cmp_gt_u32 s[62:63], v115, v19
v_cmp_gt_u32 s[66:67], v116, v19
v_cmp_gt_u32 s[70:71], v117, v19
v_cmp_gt_u32 s[74:75], v118, v19
v_cmp_gt_u32 s[78:79], v119, v19
s_waitcnt vmcnt(4)
v_max3_u32 v84, v84, v85, v86
v_max_u32 v84, v84, v87
s_nop 1
v_max_u32_dpp v84, v84, v84 row_shr:1 row_mask:0xf bank_mask:0xf bound_ctrl:0
s_nop 1
v_max_u32_dpp v84, v84, v84 row_shr:2 row_mask:0xf bank_mask:0xf bound_ctrl:0
s_nop 1
v_max_u32_dpp v84, v84, v84 row_shr:4 row_mask:0xf bank_mask:0xf bound_ctrl:0
s_nop 1
v_max_u32_dpp v84, v84, v84 row_shr:8 row_mask:0xf bank_mask:0xf bound_ctrl:0
s_nop 1
v_max_u32_dpp v84, v84, v84 row_bcast:15 row_mask:0xa bank_mask:0xf
s_nop 1
v_max_u32_dpp v84, v84, v84 row_bcast:31 row_mask:0xc bank_mask:0xf
s_mul_i32 s39, s22, 160
v_add_u32 v9, s39, v16
v_readlane_b32 s37, v84, 63
s_nop 1
v_mov_b32 v83, s37
v_mov_b32 v27, 0xc166d4ca
v_mov_b32 v10, 25600
ds_write_b32 v10, v83
v_lshlrev_b32 v72, 4, v9
v_lshlrev_b32 v73, 3, v9
v_lshl_add_u32 v74, v17, 3, v72
v_lshlrev_b32 v120, 16, v120
v_sub_f32 v10, v120, v68
v_sub_f32 v11, v120, v69
v_sub_f32 v12, v120, v70
v_sub_f32 v13, v120, v71
v_mul_f32 v10, v10, v10
v_mul_f32 v11, v11, v11
v_mul_f32 v12, v12, v12
v_mul_f32 v13, v13, v13
v_mul_f32 v10, v27, v10
v_mul_f32 v11, v27, v11
v_mul_f32 v12, v27, v12
v_mul_f32 v13, v27, v13
v_exp_f32 v10, v10
v_exp_f32 v11, v11
v_exp_f32 v12, v12
v_exp_f32 v13, v13
s_nop 0
v_cvt_pk_bf16_f32 v14, v10, v11
v_cvt_pk_bf16_f32 v15, v12, v13
s_nop 1
v_mfma_f32_32x32x8_bf16 v[80:95], v[66:67], v[14:15], 0
v_lshlrev_b32 v121, 16, v121
v_sub_f32 v10, v121, v68
v_sub_f32 v11, v121, v69
v_sub_f32 v12, v121, v70
v_sub_f32 v13, v121, v71
v_mul_f32 v10, v10, v10
v_mul_f32 v11, v11, v11
v_mul_f32 v12, v12, v12
v_mul_f32 v13, v13, v13
v_mul_f32 v10, v27, v10
v_mul_f32 v11, v27, v11
v_mul_f32 v12, v27, v12
v_mul_f32 v13, v27, v13
v_exp_f32 v10, v10
v_exp_f32 v11, v11
v_exp_f32 v12, v12
v_exp_f32 v13, v13
s_nop 0
v_cvt_pk_bf16_f32 v14, v10, v11
v_cvt_pk_bf16_f32 v15, v12, v13
s_nop 1
v_mfma_f32_32x32x8_bf16 v[96:111], v[66:67], v[14:15], 0
v_cvt_pk_f16_f32 v76, v80, v81
v_cvt_pk_f16_f32 v77, v82, v83
v_cvt_pk_f16_f32 v78, v84, v85
v_cvt_pk_f16_f32 v79, v86, v87
ds_write_b64 v74, v[76:77] offset:0
s_mov_b32 exec_hi, 0
ds_write_b64 v73, v[78:79] offset:10240
s_mov_b32 exec_hi, -1
s_mov_b32 exec_lo, 0
ds_write_b128 v72, v[84:87] offset:15360
s_mov_b32 exec_lo, -1
v_lshlrev_b32 v122, 16, v122
v_sub_f32 v10, v122, v68
v_sub_f32 v11, v122, v69
v_sub_f32 v12, v122, v70
v_sub_f32 v13, v122, v71
v_mul_f32 v10, v10, v10
v_mul_f32 v11, v11, v11
v_mul_f32 v12, v12, v12
v_mul_f32 v13, v13, v13
v_mul_f32 v10, v27, v10
v_mul_f32 v11, v27, v11
v_mul_f32 v12, v27, v12
v_mul_f32 v13, v27, v13
v_exp_f32 v10, v10
v_exp_f32 v11, v11
v_exp_f32 v12, v12
v_exp_f32 v13, v13
s_nop 0
v_cvt_pk_bf16_f32 v14, v10, v11
v_cvt_pk_bf16_f32 v15, v12, v13
s_nop 1
s_waitcnt lgkmcnt(0)
v_mfma_f32_32x32x8_bf16 v[80:95], v[66:67], v[14:15], 0
v_cvt_pk_f16_f32 v76, v96, v97
v_cvt_pk_f16_f32 v77, v98, v99
v_cvt_pk_f16_f32 v78, v100, v101
v_cvt_pk_f16_f32 v79, v102, v103
ds_write_b64 v74, v[76:77] offset:512
s_mov_b32 exec_hi, 0
ds_write_b64 v73, v[78:79] offset:10496
s_mov_b32 exec_hi, -1
s_mov_b32 exec_lo, 0
ds_write_b128 v72, v[100:103] offset:15872
s_mov_b32 exec_lo, -1
v_lshlrev_b32 v123, 16, v123
v_sub_f32 v10, v123, v68
v_sub_f32 v11, v123, v69
v_sub_f32 v12, v123, v70
v_sub_f32 v13, v123, v71
v_mul_f32 v10, v10, v10
v_mul_f32 v11, v11, v11
v_mul_f32 v12, v12, v12
v_mul_f32 v13, v13, v13
v_mul_f32 v10, v27, v10
v_mul_f32 v11, v27, v11
v_mul_f32 v12, v27, v12
v_mul_f32 v13, v27, v13
v_exp_f32 v10, v10
v_exp_f32 v11, v11
v_exp_f32 v12, v12
v_exp_f32 v13, v13
s_nop 0
v_cvt_pk_bf16_f32 v14, v10, v11
v_cvt_pk_bf16_f32 v15, v12, v13
s_nop 1
s_waitcnt lgkmcnt(0)
v_mfma_f32_32x32x8_bf16 v[96:111], v[66:67], v[14:15], 0
v_cvt_pk_f16_f32 v76, v80, v81
v_cvt_pk_f16_f32 v77, v82, v83
v_cvt_pk_f16_f32 v78, v84, v85
v_cvt_pk_f16_f32 v79, v86, v87
ds_write_b64 v74, v[76:77] offset:1024
s_mov_b32 exec_hi, 0
ds_write_b64 v73, v[78:79] offset:10752
s_mov_b32 exec_hi, -1
s_mov_b32 exec_lo, 0
ds_write_b128 v72, v[84:87] offset:16384
s_mov_b32 exec_lo, -1
v_lshlrev_b32 v124, 16, v124
v_sub_f32 v10, v124, v68
v_sub_f32 v11, v124, v69
v_sub_f32 v12, v124, v70
v_sub_f32 v13, v124, v71
v_mul_f32 v10, v10, v10
v_mul_f32 v11, v11, v11
v_mul_f32 v12, v12, v12
v_mul_f32 v13, v13, v13
v_mul_f32 v10, v27, v10
v_mul_f32 v11, v27, v11
v_mul_f32 v12, v27, v12
v_mul_f32 v13, v27, v13
v_exp_f32 v10, v10
v_exp_f32 v11, v11
v_exp_f32 v12, v12
v_exp_f32 v13, v13
s_nop 0
v_cvt_pk_bf16_f32 v14, v10, v11
v_cvt_pk_bf16_f32 v15, v12, v13
s_nop 1
s_waitcnt lgkmcnt(0)
v_mfma_f32_32x32x8_bf16 v[80:95], v[66:67], v[14:15], 0
v_cvt_pk_f16_f32 v76, v96, v97
v_cvt_pk_f16_f32 v77, v98, v99
v_cvt_pk_f16_f32 v78, v100, v101
v_cvt_pk_f16_f32 v79, v102, v103
ds_write_b64 v74, v[76:77] offset:1536
s_mov_b32 exec_hi, 0
ds_write_b64 v73, v[78:79] offset:11008
s_mov_b32 exec_hi, -1
s_mov_b32 exec_lo, 0
ds_write_b128 v72, v[100:103] offset:16896
s_mov_b32 exec_lo, -1
s_nop 7
s_nop 3
v_cvt_pk_f16_f32 v76, v80, v81
v_cvt_pk_f16_f32 v77, v82, v83
v_cvt_pk_f16_f32 v78, v84, v85
v_cvt_pk_f16_f32 v79, v86, v87
ds_write_b64 v74, v[76:77] offset:2048
s_mov_b32 exec_hi, 0
ds_write_b64 v73, v[78:79] offset:11264
s_mov_b32 exec_hi, -1
s_mov_b32 exec_lo, 0
ds_write_b128 v72, v[84:87] offset:17408
s_mov_b32 exec_lo, -1
s_branch acc_join
acc_notg:
s_cmp_lt_u32 s22, 10
s_cbranch_scc0 acc_nom
v_add_u32 v14, s36, v0
v_mov_b32 v12, 159999
v_min_u32 v14, v14, v12
v_lshlrev_b32 v14, 3, v14
global_load_dwordx2 v[4:5], v14, s[4:5]
s_load_dwordx16 s[80:95], s[34:35], 1536
s_load_dwordx4 s[44:47], s[34:35], 1648
s_waitcnt vmcnt(1)
s_branch acc_nom2
acc_nom:
s_waitcnt vmcnt(0)
acc_nom2:
v_max3_u32 v8, v112, v113, v114
v_max3_u32 v9, v115, v116, v117
v_max3_u32 v8, v8, v118, v119
v_max_u32 v8, v8, v9
v_cmp_lt_u32 vcc, 4128767, v8
s_cmp_eq_u64 vcc, 0
s_cbranch_scc0 acc_xsetup_n
acc_nox_n:
v_add_u32_sdwa v35, v2, v112 dst_sel:DWORD dst_unused:UNUSED_PAD src0_sel:DWORD src1_sel:WORD_0
v_add_u32_sdwa v39, v2, v113 dst_sel:DWORD dst_unused:UNUSED_PAD src0_sel:DWORD src1_sel:WORD_0
v_add_u32_sdwa v43, v2, v114 dst_sel:DWORD dst_unused:UNUSED_PAD src0_sel:DWORD src1_sel:WORD_0
v_add_u32_sdwa v47, v2, v115 dst_sel:DWORD dst_unused:UNUSED_PAD src0_sel:DWORD src1_sel:WORD_0
v_add_u32_sdwa v51, v2, v116 dst_sel:DWORD dst_unused:UNUSED_PAD src0_sel:DWORD src1_sel:WORD_0
v_add_u32_sdwa v55, v2, v117 dst_sel:DWORD dst_unused:UNUSED_PAD src0_sel:DWORD src1_sel:WORD_0
v_add_u32_sdwa v59, v2, v118 dst_sel:DWORD dst_unused:UNUSED_PAD src0_sel:DWORD src1_sel:WORD_0
v_add_u32_sdwa v63, v2, v119 dst_sel:DWORD dst_unused:UNUSED_PAD src0_sel:DWORD src1_sel:WORD_0
v_lshrrev_b32 v112, 16, v112
v_lshrrev_b32 v113, 16, v113
v_lshrrev_b32 v114, 16, v114
v_lshrrev_b32 v115, 16, v115
v_lshrrev_b32 v116, 16, v116
v_lshrrev_b32 v117, 16, v117
v_lshrrev_b32 v118, 16, v118
v_lshrrev_b32 v119, 16, v119
v_min_u32 v112, 62, v112
v_min_u32 v113, 62, v113
v_min_u32 v114, 62, v114
v_min_u32 v115, 62, v115
v_min_u32 v116, 62, v116
v_min_u32 v117, 62, v117
v_min_u32 v118, 62, v118
v_min_u32 v119, 62, v119
v_cmp_gt_u32 s[48:49], v112, v18
v_cmp_gt_u32 s[52:53], v113, v18
v_cmp_gt_u32 s[56:57], v114, v18
v_cmp_gt_u32 s[60:61], v115, v18
v_cmp_gt_u32 s[64:65], v116, v18
v_cmp_gt_u32 s[68:69], v117, v18
v_cmp_gt_u32 s[72:73], v118, v18
v_cmp_gt_u32 s[76:77], v119, v18
s_mov_b32 s36, 0
s_mov_b64 exec, s[48:49]
buffer_load_dwordx3 v[32:34], v35, s[24:27], s36 offen
s_mov_b32 s36, 61568
s_mov_b64 exec, s[52:53]
buffer_load_dwordx3 v[36:38], v39, s[24:27], s36 offen
s_mov_b32 s36, 123136
s_mov_b64 exec, s[56:57]
buffer_load_dwordx3 v[40:42], v43, s[24:27], s36 offen
s_mov_b32 s36, 184704
s_mov_b64 exec, s[60:61]
buffer_load_dwordx3 v[44:46], v47, s[24:27], s36 offen
s_mov_b64 exec, -1
v_cmp_gt_u32 s[50:51], v112, v19
v_cmp_gt_u32 s[54:55], v113, v19
v_cmp_gt_u32 s[58:59], v114, v19
v_cmp_gt_u32 s[62:63], v115, v19
v_cmp_gt_u32 s[66:67], v116, v19
v_cmp_gt_u32 s[70:71], v117, v19
v_cmp_gt_u32 s[74:75], v118, v19
v_cmp_gt_u32 s[78:79], v119, v19
acc_join:
v_mov_b32 v26, 8
s_mov_b32 s36, 751619
s_mov_b32 s37, 39992
v_mov_b32 v72, 0x1fffff
v_mov_b32 v77, 130
s_waitcnt vmcnt(3)
s_mov_b64 exec, s[48:49]
v_lshrrev_b32 v78, 21, v32
v_and_b32 v64, v72, v32
v_lshl_or_b32 v65, v34, 16, v78
v_mul_hi_u32_u24 v8, s36, v64
v_lshlrev_b32 v8, 2, v8
ds_add_rtn_u32 v12, v8, v26 offset:25664
v_mad_u32_u24 v73, v8, v77, s37
s_mov_b64 exec, s[50:51]
v_lshrrev_b32 v78, 21, v33
v_and_b32 v66, v72, v33
v_and_or_b32 v67, v34, v21, v78
v_mul_hi_u32_u24 v9, s36, v66
v_lshlrev_b32 v9, 2, v9
ds_add_rtn_u32 v13, v9, v26 offset:25664
v_mad_u32_u24 v74, v9, v77, s37
s_waitcnt vmcnt(2)
s_mov_b64 exec, s[52:53]
v_lshrrev_b32 v78, 21, v36
v_and_b32 v68, v72, v36
v_lshl_or_b32 v69, v38, 16, v78
v_mul_hi_u32_u24 v10, s36, v68
v_lshlrev_b32 v10, 2, v10
ds_add_rtn_u32 v14, v10, v26 offset:25664
v_mad_u32_u24 v75, v10, v77, s37
s_mov_b64 exec, s[54:55]
v_lshrrev_b32 v78, 21, v37
v_and_b32 v70, v72, v37
v_and_or_b32 v71, v38, v21, v78
v_mul_hi_u32_u24 v11, s36, v70
v_lshlrev_b32 v11, 2, v11
ds_add_rtn_u32 v15, v11, v26 offset:25664
v_mad_u32_u24 v76, v11, v77, s37
s_mov_b64 exec, s[48:49]
s_waitcnt lgkmcnt(3)
v_cmp_ge_u32 vcc, v12, v73
s_cbranch_vccnz acc_retry_0
ds_write_b64 v12, v[64:65]
acc_retry_back_0:
s_mov_b64 exec, s[50:51]
s_waitcnt lgkmcnt(3)
v_cmp_ge_u32 vcc, v13, v74
s_cbranch_vccnz acc_retry_1
ds_write_b64 v13, v[66:67]
acc_retry_back_1:
s_mov_b64 exec, s[52:53]
s_waitcnt lgkmcnt(3)
v_cmp_ge_u32 vcc, v14, v75
s_cbranch_vccnz acc_retry_2
ds_write_b64 v14, v[68:69]
acc_retry_back_2:
s_mov_b64 exec, s[54:55]
s_waitcnt lgkmcnt(3)
v_cmp_ge_u32 vcc, v15, v76
s_cbranch_vccnz acc_retry_3
ds_write_b64 v15, v[70:71]
acc_retry_back_3:
s_mov_b32 s38, 246272
s_mov_b64 exec, s[64:65]
buffer_load_dwordx3 v[48:50], v51, s[24:27], s38 offen
s_mov_b32 s38, 307840
s_mov_b64 exec, s[68:69]
buffer_load_dwordx3 v[52:54], v55, s[24:27], s38 offen
s_waitcnt vmcnt(3)
s_mov_b64 exec, s[56:57]
v_lshrrev_b32 v78, 21, v40
v_and_b32 v64, v72, v40
v_lshl_or_b32 v65, v42, 16, v78
v_mul_hi_u32_u24 v8, s36, v64
v_lshlrev_b32 v8, 2, v8
ds_add_rtn_u32 v12, v8, v26 offset:25664
v_mad_u32_u24 v73, v8, v77, s37
s_mov_b64 exec, s[58:59]
v_lshrrev_b32 v78, 21, v41
v_and_b32 v66, v72, v41
v_and_or_b32 v67, v42, v21, v78
v_mul_hi_u32_u24 v9, s36, v66
v_lshlrev_b32 v9, 2, v9
ds_add_rtn_u32 v13, v9, v26 offset:25664
v_mad_u32_u24 v74, v9, v77, s37
s_waitcnt vmcnt(2)
s_mov_b64 exec, s[60:61]
v_lshrrev_b32 v78, 21, v44
v_and_b32 v68, v72, v44
v_lshl_or_b32 v69, v46, 16, v78
v_mul_hi_u32_u24 v10, s36, v68
v_lshlrev_b32 v10, 2, v10
ds_add_rtn_u32 v14, v10, v26 offset:25664
v_mad_u32_u24 v75, v10, v77, s37
s_mov_b64 exec, s[62:63]
v_lshrrev_b32 v78, 21, v45
v_and_b32 v70, v72, v45
v_and_or_b32 v71, v46, v21, v78
v_mul_hi_u32_u24 v11, s36, v70
v_lshlrev_b32 v11, 2, v11
ds_add_rtn_u32 v15, v11, v26 offset:25664
v_mad_u32_u24 v76, v11, v77, s37
s_mov_b64 exec, s[56:57]
s_waitcnt lgkmcnt(3)
v_cmp_ge_u32 vcc, v12, v73
s_cbranch_vccnz acc_retry_4
ds_write_b64 v12, v[64:65]
acc_retry_back_4:
s_mov_b64 exec, s[58:59]
s_waitcnt lgkmcnt(3)
v_cmp_ge_u32 vcc, v13, v74
s_cbranch_vccnz acc_retry_5
ds_write_b64 v13, v[66:67]
acc_retry_back_5:
s_mov_b64 exec, s[60:61]
s_waitcnt lgkmcnt(3)
v_cmp_ge_u32 vcc, v14, v75
s_cbranch_vccnz acc_retry_6
ds_write_b64 v14, v[68:69]
acc_retry_back_6:
s_mov_b64 exec, s[62:63]
s_waitcnt lgkmcnt(3)
v_cmp_ge_u32 vcc, v15, v76
s_cbranch_vccnz acc_retry_7
ds_write_b64 v15, v[70:71]
acc_retry_back_7:
s_mov_b32 s38, 369408
s_mov_b64 exec, s[72:73]
buffer_load_dwordx3 v[56:58], v59, s[24:27], s38 offen
s_mov_b32 s38, 430976
s_mov_b64 exec, s[76:77]
buffer_load_dwordx3 v[60:62], v63, s[24:27], s38 offen
s_waitcnt vmcnt(3)
s_mov_b64 exec, s[64:65]
v_lshrrev_b32 v78, 21, v48
v_and_b32 v64, v72, v48
v_lshl_or_b32 v65, v50, 16, v78
v_mul_hi_u32_u24 v8, s36, v64
v_lshlrev_b32 v8, 2, v8
ds_add_rtn_u32 v12, v8, v26 offset:25664
v_mad_u32_u24 v73, v8, v77, s37
s_mov_b64 exec, s[66:67]
v_lshrrev_b32 v78, 21, v49
v_and_b32 v66, v72, v49
v_and_or_b32 v67, v50, v21, v78
v_mul_hi_u32_u24 v9, s36, v66
v_lshlrev_b32 v9, 2, v9
ds_add_rtn_u32 v13, v9, v26 offset:25664
v_mad_u32_u24 v74, v9, v77, s37
s_waitcnt vmcnt(2)
s_mov_b64 exec, s[68:69]
v_lshrrev_b32 v78, 21, v52
v_and_b32 v68, v72, v52
v_lshl_or_b32 v69, v54, 16, v78
v_mul_hi_u32_u24 v10, s36, v68
v_lshlrev_b32 v10, 2, v10
ds_add_rtn_u32 v14, v10, v26 offset:25664
v_mad_u32_u24 v75, v10, v77, s37
s_mov_b64 exec, s[70:71]
v_lshrrev_b32 v78, 21, v53
v_and_b32 v70, v72, v53
v_and_or_b32 v71, v54, v21, v78
v_mul_hi_u32_u24 v11, s36, v70
v_lshlrev_b32 v11, 2, v11
ds_add_rtn_u32 v15, v11, v26 offset:25664
v_mad_u32_u24 v76, v11, v77, s37
s_mov_b64 exec, s[64:65]
s_waitcnt lgkmcnt(3)
v_cmp_ge_u32 vcc, v12, v73
s_cbranch_vccnz acc_retry_8
ds_write_b64 v12, v[64:65]
acc_retry_back_8:
s_mov_b64 exec, s[66:67]
s_waitcnt lgkmcnt(3)
v_cmp_ge_u32 vcc, v13, v74
s_cbranch_vccnz acc_retry_9
ds_write_b64 v13, v[66:67]
acc_retry_back_9:
s_mov_b64 exec, s[68:69]
s_waitcnt lgkmcnt(3)
v_cmp_ge_u32 vcc, v14, v75
s_cbranch_vccnz acc_retry_10
ds_write_b64 v14, v[68:69]
acc_retry_back_10:
s_mov_b64 exec, s[70:71]
s_waitcnt lgkmcnt(3)
v_cmp_ge_u32 vcc, v15, v76
s_cbranch_vccnz acc_retry_11
ds_write_b64 v15, v[70:71]
acc_retry_back_11:
s_waitcnt vmcnt(1)
s_mov_b64 exec, s[72:73]
v_lshrrev_b32 v78, 21, v56
v_and_b32 v64, v72, v56
v_lshl_or_b32 v65, v58, 16, v78
v_mul_hi_u32_u24 v8, s36, v64
v_lshlrev_b32 v8, 2, v8
ds_add_rtn_u32 v12, v8, v26 offset:25664
v_mad_u32_u24 v73, v8, v77, s37
s_mov_b64 exec, s[74:75]
v_lshrrev_b32 v78, 21, v57
v_and_b32 v66, v72, v57
v_and_or_b32 v67, v58, v21, v78
v_mul_hi_u32_u24 v9, s36, v66
v_lshlrev_b32 v9, 2, v9
ds_add_rtn_u32 v13, v9, v26 offset:25664
v_mad_u32_u24 v74, v9, v77, s37
s_waitcnt vmcnt(0)
s_mov_b64 exec, s[76:77]
v_lshrrev_b32 v78, 21, v60
v_and_b32 v68, v72, v60
v_lshl_or_b32 v69, v62, 16, v78
v_mul_hi_u32_u24 v10, s36, v68
v_lshlrev_b32 v10, 2, v10
ds_add_rtn_u32 v14, v10, v26 offset:25664
v_mad_u32_u24 v75, v10, v77, s37
s_mov_b64 exec, s[78:79]
v_lshrrev_b32 v78, 21, v61
v_and_b32 v70, v72, v61
v_and_or_b32 v71, v62, v21, v78
v_mul_hi_u32_u24 v11, s36, v70
v_lshlrev_b32 v11, 2, v11
ds_add_rtn_u32 v15, v11, v26 offset:25664
v_mad_u32_u24 v76, v11, v77, s37
s_mov_b64 exec, s[72:73]
s_waitcnt lgkmcnt(3)
v_cmp_ge_u32 vcc, v12, v73
s_cbranch_vccnz acc_retry_12
ds_write_b64 v12, v[64:65]
acc_retry_back_12:
s_mov_b64 exec, s[74:75]
s_waitcnt lgkmcnt(3)
v_cmp_ge_u32 vcc, v13, v74
s_cbranch_vccnz acc_retry_13
ds_write_b64 v13, v[66:67]
acc_retry_back_13:
s_mov_b64 exec, s[76:77]
s_waitcnt lgkmcnt(3)
v_cmp_ge_u32 vcc, v14, v75
s_cbranch_vccnz acc_retry_14
ds_write_b64 v14, v[68:69]
acc_retry_back_14:
s_mov_b64 exec, s[78:79]
s_waitcnt lgkmcnt(3)
v_cmp_ge_u32 vcc, v15, v76
s_cbranch_vccnz acc_retry_15
ds_write_b64 v15, v[70:71]
acc_retry_back_15:
s_cmp_eq_u32 s10, 0
s_cbranch_scc1 acc_x1
s_mov_b64 exec, s[8:9]
v_lshrrev_b32 v78, 21, v28
v_and_b32 v64, v72, v28
v_lshl_or_b32 v65, v30, 16, v78
v_mul_hi_u32_u24 v8, s36, v64
v_lshlrev_b32 v8, 2, v8
ds_add_rtn_u32 v12, v8, v26 offset:25664
v_mad_u32_u24 v73, v8, v77, s37
s_mov_b64 exec, s[40:41]
v_lshrrev_b32 v78, 21, v29
v_and_b32 v66, v72, v29
v_and_or_b32 v67, v30, v21, v78
v_mul_hi_u32_u24 v9, s36, v66
v_lshlrev_b32 v9, 2, v9
ds_add_rtn_u32 v13, v9, v26 offset:25664
v_mad_u32_u24 v74, v9, v77, s37
s_mov_b64 exec, s[8:9]
s_waitcnt lgkmcnt(1)
v_cmp_ge_u32 vcc, v12, v73
s_cbranch_vccnz acc_retry_16
ds_write_b64 v12, v[64:65]
acc_retry_back_16:
s_mov_b64 exec, s[40:41]
s_waitcnt lgkmcnt(1)
v_cmp_ge_u32 vcc, v13, v74
s_cbranch_vccnz acc_retry_17
ds_write_b64 v13, v[66:67]
acc_retry_back_17:
acc_x1:
s_mov_b64 exec, -1
s_waitcnt lgkmcnt(0)
s_barrier
v_mov_b32 v14, 64
s_cmp_lg_u32 s23, 0
s_cbranch_scc1 acc_save
acc_save_back:
acc_pass:
v_lshlrev_b32 v8, 6, v1
s_lshl_b32 s36, s22, 2
v_add_u32 v8, s36, v8
v_mov_b32 v9, 25600
ds_read_b32 v11, v8 offset:25664
ds_read_b32 v15, v9
ds_read_b64 v[32:33], v20 offset:0
ds_read_b64 v[34:35], v20 offset:8320
ds_read_b64 v[36:37], v20 offset:16640
ds_read_b64 v[38:39], v20 offset:24960
ds_read_b64 v[40:41], v20 offset:33280
ds_read_b64 v[42:43], v20 offset:41600
ds_read_b64 v[44:45], v20 offset:49920
ds_read_b64 v[46:47], v7 offset:0
ds_read_b64 v[48:49], v7 offset:8320
ds_read_b64 v[50:51], v7 offset:16640
ds_read_b64 v[52:53], v7 offset:24960
ds_read_b64 v[54:55], v7 offset:33280
ds_read_b64 v[56:57], v7 offset:41600
ds_read_b64 v[58:59], v7 offset:49920
v_mul_u32_u24 v13, 8320, v1
s_mul_i32 s36, s22, 520
s_add_u32 s36, s36, 39488
v_add_u32 v13, s36, v13
v_mov_b32 v22, s12
v_mov_b32 v23, s13
v_mov_b32 v24, s14
v_mov_b32 v73, 0
v_mov_b32 v74, 0
v_mov_b32 v75, 0
v_mov_b32 v76, 1
s_waitcnt lgkmcnt(15)
v_sub_u32 v11, v11, v13
v_lshrrev_b32 v11, 3, v11
v_min_u32 v11, 63, v11
s_nop 0
v_readlane_b32 s48, v11, 0
v_readlane_b32 s50, v11, 1
v_readlane_b32 s52, v11, 2
v_readlane_b32 s54, v11, 3
s_bfm_b64 s[48:49], s48, 0
s_bfm_b64 s[50:51], s50, 0
s_bfm_b64 s[52:53], s52, 0
s_bfm_b64 s[54:55], s54, 0
s_waitcnt lgkmcnt(13)
s_mov_b64 exec, s[48:49]
buffer_load_dwordx2 v[64:65], v32, s[28:31], 0 offen
s_waitcnt lgkmcnt(12)
s_mov_b64 exec, s[50:51]
buffer_load_dwordx2 v[66:67], v34, s[28:31], 0 offen
s_waitcnt lgkmcnt(11)
s_mov_b64 exec, s[52:53]
buffer_load_dwordx2 v[68:69], v36, s[28:31], 0 offen
s_waitcnt lgkmcnt(10)
s_mov_b64 exec, s[54:55]
buffer_load_dwordx2 v[70:71], v38, s[28:31], 0 offen
v_readlane_b32 s56, v11, 4
v_readlane_b32 s58, v11, 5
v_readlane_b32 s60, v11, 6
v_readlane_b32 s62, v11, 7
v_readlane_b32 s64, v11, 8
v_readlane_b32 s66, v11, 9
v_readlane_b32 s68, v11, 10
v_readlane_b32 s70, v11, 11
v_readlane_b32 s72, v11, 12
v_readlane_b32 s74, v11, 13
s_bfm_b64 s[56:57], s56, 0
s_bfm_b64 s[58:59], s58, 0
s_bfm_b64 s[60:61], s60, 0
s_bfm_b64 s[62:63], s62, 0
s_bfm_b64 s[64:65], s64, 0
s_bfm_b64 s[66:67], s66, 0
s_bfm_b64 s[68:69], s68, 0
s_bfm_b64 s[70:71], s70, 0
s_bfm_b64 s[72:73], s72, 0
s_bfm_b64 s[74:75], s74, 0
s_mov_b64 exec, -1
v_cvt_f32_u32 v14, v14
v_mov_b32 v26, 60
v_mov_b32 v27, -60
v_mul_f32 v14, v15, v14
v_mul_f32 v14, 0x3f820000, v14
v_frexp_exp_i32_f32 v14, v14
v_sub_u32 v14, 31, v14
v_med3_i32 v6, v14, v27, v26
v_mov_b32 v26, 1.0
v_ldexp_f32 v26, v26, v6
s_mul_i32 s39, s3, 625
v_add_u32 v77, s39, v0
v_lshlrev_b32 v77, 3, v77
v_lshlrev_b32 v88, 16, v4
v_and_b32 v89, v21, v4
v_lshlrev_b32 v90, 16, v5
v_and_b32 v91, v21, v5
v_lshlrev_b32 v102, 2, v0
v_lshlrev_b32 v103, 4, v0
v_mov_b32 v79, 25608
v_add_u32 v98, s44, v6
v_add_u32 v99, s45, v6
v_add_u32 v100, s46, v6
v_add_u32 v101, s47, v6
v_sub_u32 v98, 0, v98
v_sub_u32 v99, 0, v99
v_sub_u32 v100, 0, v100
v_sub_u32 v101, 0, v101
s_cmp_lt_u32 s22, 10
s_cbranch_scc0 acc_fin_skip
ds_read_b128 v[16:19], v103 offset:15360
acc_fin_skip:
s_mov_b64 exec, s[48:49]
v_lshlrev_b32_sdwa v106, 4, v33 dst_sel:DWORD dst_unused:UNUSED_PAD src0_sel:DWORD src1_sel:WORD_0
v_lshlrev_b32_sdwa v104, 3, v33 dst_sel:DWORD dst_unused:UNUSED_PAD src0_sel:DWORD src1_sel:WORD_0
ds_read_b128 v[80:83], v106 offset:0
ds_read_b64 v[84:85], v104 offset:10240
v_lshlrev_b32_sdwa v86, 2, v33 dst_sel:DWORD dst_unused:UNUSED_PAD src0_sel:DWORD src1_sel:WORD_0
s_mov_b64 exec, s[50:51]
v_lshlrev_b32_sdwa v106, 4, v35 dst_sel:DWORD dst_unused:UNUSED_PAD src0_sel:DWORD src1_sel:WORD_0
v_lshlrev_b32_sdwa v105, 3, v35 dst_sel:DWORD dst_unused:UNUSED_PAD src0_sel:DWORD src1_sel:WORD_0
ds_read_b128 v[92:95], v106 offset:0
ds_read_b64 v[96:97], v105 offset:10240
v_lshlrev_b32_sdwa v87, 2, v35 dst_sel:DWORD dst_unused:UNUSED_PAD src0_sel:DWORD src1_sel:WORD_0
s_mov_b64 exec, s[48:49]
v_and_b32 v107, v21, v33
v_mul_f32 v108, v22, v107
v_mul_f32 v109, v23, v107
v_mul_f32 v110, v24, v107
v_fract_f32 v108, v108
v_fract_f32 v109, v109
v_fract_f32 v110, v110
v_cos_f32 v108, v108
v_cos_f32 v109, v109
v_cos_f32 v110, v110
s_waitcnt vmcnt(3)
v_lshlrev_b32 v112, 16, v64
v_and_b32 v113, v21, v64
v_mul_f32 v108, v26, v108
v_mul_f32 v109, v26, v109
v_mul_f32 v110, v26, v110
v_lshlrev_b32 v114, 16, v65
v_and_b32 v115, v21, v65
s_waitcnt lgkmcnt(2)
v_max_u32 v75, v75, v73
v_fma_mix_f32 v116, v108, v80, 0 op_sel:[0,0,0] op_sel_hi:[0,1,0]
v_fma_mix_f32 v117, v108, v80, 0 op_sel:[0,1,0] op_sel_hi:[0,1,0]
v_fma_mix_f32 v118, v108, v81, 0 op_sel:[0,0,0] op_sel_hi:[0,1,0]
v_fma_mix_f32 v119, v108, v81, 0 op_sel:[0,1,0] op_sel_hi:[0,1,0]
v_fma_mix_f32 v116, v109, v82, v116 op_sel:[0,0,0] op_sel_hi:[0,1,0]
v_fma_mix_f32 v117, v109, v82, v117 op_sel:[0,1,0] op_sel_hi:[0,1,0]
v_fma_mix_f32 v118, v109, v83, v118 op_sel:[0,0,0] op_sel_hi:[0,1,0]
v_fma_mix_f32 v119, v109, v83, v119 op_sel:[0,1,0] op_sel_hi:[0,1,0]
v_fma_mix_f32 v116, v110, v84, v116 op_sel:[0,0,0] op_sel_hi:[0,1,0]
v_fma_mix_f32 v117, v110, v84, v117 op_sel:[0,1,0] op_sel_hi:[0,1,0]
v_fma_mix_f32 v118, v110, v85, v118 op_sel:[0,0,0] op_sel_hi:[0,1,0]
v_fma_mix_f32 v119, v110, v85, v119 op_sel:[0,1,0] op_sel_hi:[0,1,0]
v_pk_mul_f32 v[116:117], v[116:117], v[112:113]
v_pk_mul_f32 v[118:119], v[118:119], v[114:115]
v_cvt_rpi_i32_f32 v116, v116
v_cvt_rpi_i32_f32 v117, v117
v_cvt_rpi_i32_f32 v118, v118
v_cvt_rpi_i32_f32 v119, v119
ds_add_u32 v86, v116 offset:29248
ds_add_u32 v86, v117 offset:31808
ds_add_u32 v86, v118 offset:34368
ds_add_u32 v86, v119 offset:36928
ds_add_rtn_u32 v73, v86, v76 offset:26688
s_mov_b64 exec, s[56:57]
buffer_load_dwordx2 v[64:65], v40, s[28:31], 0 offen
s_mov_b64 exec, s[52:53]
v_lshlrev_b32_sdwa v106, 4, v37 dst_sel:DWORD dst_unused:UNUSED_PAD src0_sel:DWORD src1_sel:WORD_0
v_lshlrev_b32_sdwa v104, 3, v37 dst_sel:DWORD dst_unused:UNUSED_PAD src0_sel:DWORD src1_sel:WORD_0
ds_read_b128 v[80:83], v106 offset:0
ds_read_b64 v[84:85], v104 offset:10240
v_lshlrev_b32_sdwa v86, 2, v37 dst_sel:DWORD dst_unused:UNUSED_PAD src0_sel:DWORD src1_sel:WORD_0
s_mov_b64 exec, s[50:51]
v_and_b32 v107, v21, v35
v_mul_f32 v108, v22, v107
v_mul_f32 v109, v23, v107
v_mul_f32 v110, v24, v107
v_fract_f32 v108, v108
v_fract_f32 v109, v109
v_fract_f32 v110, v110
v_cos_f32 v108, v108
v_cos_f32 v109, v109
v_cos_f32 v110, v110
s_waitcnt vmcnt(3)
v_lshlrev_b32 v112, 16, v66
v_and_b32 v113, v21, v66
v_mul_f32 v108, v26, v108
v_mul_f32 v109, v26, v109
v_mul_f32 v110, v26, v110
v_lshlrev_b32 v114, 16, v67
v_and_b32 v115, v21, v67
s_waitcnt lgkmcnt(7)
v_max_u32 v75, v75, v74
v_fma_mix_f32 v116, v108, v92, 0 op_sel:[0,0,0] op_sel_hi:[0,1,0]
v_fma_mix_f32 v117, v108, v92, 0 op_sel:[0,1,0] op_sel_hi:[0,1,0]
v_fma_mix_f32 v118, v108, v93, 0 op_sel:[0,0,0] op_sel_hi:[0,1,0]
v_fma_mix_f32 v119, v108, v93, 0 op_sel:[0,1,0] op_sel_hi:[0,1,0]
v_fma_mix_f32 v116, v109, v94, v116 op_sel:[0,0,0] op_sel_hi:[0,1,0]
v_fma_mix_f32 v117, v109, v94, v117 op_sel:[0,1,0] op_sel_hi:[0,1,0]
v_fma_mix_f32 v118, v109, v95, v118 op_sel:[0,0,0] op_sel_hi:[0,1,0]
v_fma_mix_f32 v119, v109, v95, v119 op_sel:[0,1,0] op_sel_hi:[0,1,0]
v_fma_mix_f32 v116, v110, v96, v116 op_sel:[0,0,0] op_sel_hi:[0,1,0]
v_fma_mix_f32 v117, v110, v96, v117 op_sel:[0,1,0] op_sel_hi:[0,1,0]
v_fma_mix_f32 v118, v110, v97, v118 op_sel:[0,0,0] op_sel_hi:[0,1,0]
v_fma_mix_f32 v119, v110, v97, v119 op_sel:[0,1,0] op_sel_hi:[0,1,0]
v_pk_mul_f32 v[116:117], v[116:117], v[112:113]
v_pk_mul_f32 v[118:119], v[118:119], v[114:115]
v_cvt_rpi_i32_f32 v116, v116
v_cvt_rpi_i32_f32 v117, v117
v_cvt_rpi_i32_f32 v118, v118
v_cvt_rpi_i32_f32 v119, v119
ds_add_u32 v87, v116 offset:29248
ds_add_u32 v87, v117 offset:31808
ds_add_u32 v87, v118 offset:34368
ds_add_u32 v87, v119 offset:36928
ds_add_rtn_u32 v74, v87, v76 offset:26688
s_mov_b64 exec, s[58:59]
buffer_load_dwordx2 v[66:67], v42, s[28:31], 0 offen
s_mov_b64 exec, s[54:55]
v_lshlrev_b32_sdwa v106, 4, v39 dst_sel:DWORD dst_unused:UNUSED_PAD src0_sel:DWORD src1_sel:WORD_0
v_lshlrev_b32_sdwa v105, 3, v39 dst_sel:DWORD dst_unused:UNUSED_PAD src0_sel:DWORD src1_sel:WORD_0
ds_read_b128 v[92:95], v106 offset:0
ds_read_b64 v[96:97], v105 offset:10240
v_lshlrev_b32_sdwa v87, 2, v39 dst_sel:DWORD dst_unused:UNUSED_PAD src0_sel:DWORD src1_sel:WORD_0
s_mov_b64 exec, s[52:53]
v_and_b32 v107, v21, v37
v_mul_f32 v108, v22, v107
v_mul_f32 v109, v23, v107
v_mul_f32 v110, v24, v107
v_fract_f32 v108, v108
v_fract_f32 v109, v109
v_fract_f32 v110, v110
v_cos_f32 v108, v108
v_cos_f32 v109, v109
v_cos_f32 v110, v110
s_waitcnt vmcnt(3)
v_lshlrev_b32 v112, 16, v68
v_and_b32 v113, v21, v68
v_mul_f32 v108, v26, v108
v_mul_f32 v109, v26, v109
v_mul_f32 v110, v26, v110
v_lshlrev_b32 v114, 16, v69
v_and_b32 v115, v21, v69
s_waitcnt lgkmcnt(7)
v_max_u32 v75, v75, v73
v_fma_mix_f32 v116, v108, v80, 0 op_sel:[0,0,0] op_sel_hi:[0,1,0]
v_fma_mix_f32 v117, v108, v80, 0 op_sel:[0,1,0] op_sel_hi:[0,1,0]
v_fma_mix_f32 v118, v108, v81, 0 op_sel:[0,0,0] op_sel_hi:[0,1,0]
v_fma_mix_f32 v119, v108, v81, 0 op_sel:[0,1,0] op_sel_hi:[0,1,0]
v_fma_mix_f32 v116, v109, v82, v116 op_sel:[0,0,0] op_sel_hi:[0,1,0]
v_fma_mix_f32 v117, v109, v82, v117 op_sel:[0,1,0] op_sel_hi:[0,1,0]
v_fma_mix_f32 v118, v109, v83, v118 op_sel:[0,0,0] op_sel_hi:[0,1,0]
v_fma_mix_f32 v119, v109, v83, v119 op_sel:[0,1,0] op_sel_hi:[0,1,0]
v_fma_mix_f32 v116, v110, v84, v116 op_sel:[0,0,0] op_sel_hi:[0,1,0]
v_fma_mix_f32 v117, v110, v84, v117 op_sel:[0,1,0] op_sel_hi:[0,1,0]
v_fma_mix_f32 v118, v110, v85, v118 op_sel:[0,0,0] op_sel_hi:[0,1,0]
v_fma_mix_f32 v119, v110, v85, v119 op_sel:[0,1,0] op_sel_hi:[0,1,0]
v_pk_mul_f32 v[116:117], v[116:117], v[112:113]
v_pk_mul_f32 v[118:119], v[118:119], v[114:115]
v_cvt_rpi_i32_f32 v116, v116
v_cvt_rpi_i32_f32 v117, v117
v_cvt_rpi_i32_f32 v118, v118
v_cvt_rpi_i32_f32 v119, v119
ds_add_u32 v86, v116 offset:29248
ds_add_u32 v86, v117 offset:31808
ds_add_u32 v86, v118 offset:34368
ds_add_u32 v86, v119 offset:36928
ds_add_rtn_u32 v73, v86, v76 offset:26688
s_mov_b64 exec, s[60:61]
buffer_load_dwordx2 v[68:69], v44, s[28:31], 0 offen
s_mov_b64 exec, s[56:57]
v_lshlrev_b32_sdwa v106, 4, v41 dst_sel:DWORD dst_unused:UNUSED_PAD src0_sel:DWORD src1_sel:WORD_0
v_lshlrev_b32_sdwa v104, 3, v41 dst_sel:DWORD dst_unused:UNUSED_PAD src0_sel:DWORD src1_sel:WORD_0
ds_read_b128 v[80:83], v106 offset:0
ds_read_b64 v[84:85], v104 offset:10240
v_lshlrev_b32_sdwa v86, 2, v41 dst_sel:DWORD dst_unused:UNUSED_PAD src0_sel:DWORD src1_sel:WORD_0
s_mov_b64 exec, s[54:55]
v_and_b32 v107, v21, v39
v_mul_f32 v108, v22, v107
v_mul_f32 v109, v23, v107
v_mul_f32 v110, v24, v107
v_fract_f32 v108, v108
v_fract_f32 v109, v109
v_fract_f32 v110, v110
v_cos_f32 v108, v108
v_cos_f32 v109, v109
v_cos_f32 v110, v110
s_waitcnt vmcnt(3)
v_lshlrev_b32 v112, 16, v70
v_and_b32 v113, v21, v70
v_mul_f32 v108, v26, v108
v_mul_f32 v109, v26, v109
v_mul_f32 v110, v26, v110
v_lshlrev_b32 v114, 16, v71
v_and_b32 v115, v21, v71
s_waitcnt lgkmcnt(7)
v_max_u32 v75, v75, v74
v_fma_mix_f32 v116, v108, v92, 0 op_sel:[0,0,0] op_sel_hi:[0,1,0]
v_fma_mix_f32 v117, v108, v92, 0 op_sel:[0,1,0] op_sel_hi:[0,1,0]
v_fma_mix_f32 v118, v108, v93, 0 op_sel:[0,0,0] op_sel_hi:[0,1,0]
v_fma_mix_f32 v119, v108, v93, 0 op_sel:[0,1,0] op_sel_hi:[0,1,0]
v_fma_mix_f32 v116, v109, v94, v116 op_sel:[0,0,0] op_sel_hi:[0,1,0]
v_fma_mix_f32 v117, v109, v94, v117 op_sel:[0,1,0] op_sel_hi:[0,1,0]
v_fma_mix_f32 v118, v109, v95, v118 op_sel:[0,0,0] op_sel_hi:[0,1,0]
v_fma_mix_f32 v119, v109, v95, v119 op_sel:[0,1,0] op_sel_hi:[0,1,0]
v_fma_mix_f32 v116, v110, v96, v116 op_sel:[0,0,0] op_sel_hi:[0,1,0]
v_fma_mix_f32 v117, v110, v96, v117 op_sel:[0,1,0] op_sel_hi:[0,1,0]
v_fma_mix_f32 v118, v110, v97, v118 op_sel:[0,0,0] op_sel_hi:[0,1,0]
v_fma_mix_f32 v119, v110, v97, v119 op_sel:[0,1,0] op_sel_hi:[0,1,0]
v_pk_mul_f32 v[116:117], v[116:117], v[112:113]
v_pk_mul_f32 v[118:119], v[118:119], v[114:115]
v_cvt_rpi_i32_f32 v116, v116
v_cvt_rpi_i32_f32 v117, v117
v_cvt_rpi_i32_f32 v118, v118
v_cvt_rpi_i32_f32 v119, v119
ds_add_u32 v87, v116 offset:29248
ds_add_u32 v87, v117 offset:31808
ds_add_u32 v87, v118 offset:34368
ds_add_u32 v87, v119 offset:36928
ds_add_rtn_u32 v74, v87, v76 offset:26688
s_mov_b64 exec, s[62:63]
buffer_load_dwordx2 v[70:71], v46, s[28:31], 0 offen
s_mov_b64 exec, s[58:59]
v_lshlrev_b32_sdwa v106, 4, v43 dst_sel:DWORD dst_unused:UNUSED_PAD src0_sel:DWORD src1_sel:WORD_0
v_lshlrev_b32_sdwa v105, 3, v43 dst_sel:DWORD dst_unused:UNUSED_PAD src0_sel:DWORD src1_sel:WORD_0
ds_read_b128 v[92:95], v106 offset:0
ds_read_b64 v[96:97], v105 offset:10240
v_lshlrev_b32_sdwa v87, 2, v43 dst_sel:DWORD dst_unused:UNUSED_PAD src0_sel:DWORD src1_sel:WORD_0
s_mov_b64 exec, s[56:57]
v_and_b32 v107, v21, v41
v_mul_f32 v108, v22, v107
v_mul_f32 v109, v23, v107
v_mul_f32 v110, v24, v107
v_fract_f32 v108, v108
v_fract_f32 v109, v109
v_fract_f32 v110, v110
v_cos_f32 v108, v108
v_cos_f32 v109, v109
v_cos_f32 v110, v110
s_waitcnt vmcnt(3)
v_lshlrev_b32 v112, 16, v64
v_and_b32 v113, v21, v64
v_mul_f32 v108, v26, v108
v_mul_f32 v109, v26, v109
v_mul_f32 v110, v26, v110
v_lshlrev_b32 v114, 16, v65
v_and_b32 v115, v21, v65
s_waitcnt lgkmcnt(7)
v_max_u32 v75, v75, v73
v_fma_mix_f32 v116, v108, v80, 0 op_sel:[0,0,0] op_sel_hi:[0,1,0]
v_fma_mix_f32 v117, v108, v80, 0 op_sel:[0,1,0] op_sel_hi:[0,1,0]
v_fma_mix_f32 v118, v108, v81, 0 op_sel:[0,0,0] op_sel_hi:[0,1,0]
v_fma_mix_f32 v119, v108, v81, 0 op_sel:[0,1,0] op_sel_hi:[0,1,0]
v_fma_mix_f32 v116, v109, v82, v116 op_sel:[0,0,0] op_sel_hi:[0,1,0]
v_fma_mix_f32 v117, v109, v82, v117 op_sel:[0,1,0] op_sel_hi:[0,1,0]
v_fma_mix_f32 v118, v109, v83, v118 op_sel:[0,0,0] op_sel_hi:[0,1,0]
v_fma_mix_f32 v119, v109, v83, v119 op_sel:[0,1,0] op_sel_hi:[0,1,0]
v_fma_mix_f32 v116, v110, v84, v116 op_sel:[0,0,0] op_sel_hi:[0,1,0]
v_fma_mix_f32 v117, v110, v84, v117 op_sel:[0,1,0] op_sel_hi:[0,1,0]
v_fma_mix_f32 v118, v110, v85, v118 op_sel:[0,0,0] op_sel_hi:[0,1,0]
v_fma_mix_f32 v119, v110, v85, v119 op_sel:[0,1,0] op_sel_hi:[0,1,0]
v_pk_mul_f32 v[116:117], v[116:117], v[112:113]
v_pk_mul_f32 v[118:119], v[118:119], v[114:115]
v_cvt_rpi_i32_f32 v116, v116
v_cvt_rpi_i32_f32 v117, v117
v_cvt_rpi_i32_f32 v118, v118
v_cvt_rpi_i32_f32 v119, v119
ds_add_u32 v86, v116 offset:29248
ds_add_u32 v86, v117 offset:31808
ds_add_u32 v86, v118 offset:34368
ds_add_u32 v86, v119 offset:36928
ds_add_rtn_u32 v73, v86, v76 offset:26688
s_mov_b64 exec, s[64:65]
buffer_load_dwordx2 v[64:65], v48, s[28:31], 0 offen
s_mov_b64 exec, s[60:61]
v_lshlrev_b32_sdwa v106, 4, v45 dst_sel:DWORD dst_unused:UNUSED_PAD src0_sel:DWORD src1_sel:WORD_0
v_lshlrev_b32_sdwa v104, 3, v45 dst_sel:DWORD dst_unused:UNUSED_PAD src0_sel:DWORD src1_sel:WORD_0
ds_read_b128 v[80:83], v106 offset:0
ds_read_b64 v[84:85], v104 offset:10240
v_lshlrev_b32_sdwa v86, 2, v45 dst_sel:DWORD dst_unused:UNUSED_PAD src0_sel:DWORD src1_sel:WORD_0
s_mov_b64 exec, s[58:59]
v_and_b32 v107, v21, v43
v_mul_f32 v108, v22, v107
v_mul_f32 v109, v23, v107
v_mul_f32 v110, v24, v107
v_fract_f32 v108, v108
v_fract_f32 v109, v109
v_fract_f32 v110, v110
v_cos_f32 v108, v108
v_cos_f32 v109, v109
v_cos_f32 v110, v110
s_waitcnt vmcnt(3)
v_lshlrev_b32 v112, 16, v66
v_and_b32 v113, v21, v66
v_mul_f32 v108, v26, v108
v_mul_f32 v109, v26, v109
v_mul_f32 v110, v26, v110
v_lshlrev_b32 v114, 16, v67
v_and_b32 v115, v21, v67
s_waitcnt lgkmcnt(7)
v_max_u32 v75, v75, v74
v_fma_mix_f32 v116, v108, v92, 0 op_sel:[0,0,0] op_sel_hi:[0,1,0]
v_fma_mix_f32 v117, v108, v92, 0 op_sel:[0,1,0] op_sel_hi:[0,1,0]
v_fma_mix_f32 v118, v108, v93, 0 op_sel:[0,0,0] op_sel_hi:[0,1,0]
v_fma_mix_f32 v119, v108, v93, 0 op_sel:[0,1,0] op_sel_hi:[0,1,0]
v_fma_mix_f32 v116, v109, v94, v116 op_sel:[0,0,0] op_sel_hi:[0,1,0]
v_fma_mix_f32 v117, v109, v94, v117 op_sel:[0,1,0] op_sel_hi:[0,1,0]
v_fma_mix_f32 v118, v109, v95, v118 op_sel:[0,0,0] op_sel_hi:[0,1,0]
v_fma_mix_f32 v119, v109, v95, v119 op_sel:[0,1,0] op_sel_hi:[0,1,0]
v_fma_mix_f32 v116, v110, v96, v116 op_sel:[0,0,0] op_sel_hi:[0,1,0]
v_fma_mix_f32 v117, v110, v96, v117 op_sel:[0,1,0] op_sel_hi:[0,1,0]
v_fma_mix_f32 v118, v110, v97, v118 op_sel:[0,0,0] op_sel_hi:[0,1,0]
v_fma_mix_f32 v119, v110, v97, v119 op_sel:[0,1,0] op_sel_hi:[0,1,0]
v_pk_mul_f32 v[116:117], v[116:117], v[112:113]
v_pk_mul_f32 v[118:119], v[118:119], v[114:115]
v_cvt_rpi_i32_f32 v116, v116
v_cvt_rpi_i32_f32 v117, v117
v_cvt_rpi_i32_f32 v118, v118
v_cvt_rpi_i32_f32 v119, v119
ds_add_u32 v87, v116 offset:29248
ds_add_u32 v87, v117 offset:31808
ds_add_u32 v87, v118 offset:34368
ds_add_u32 v87, v119 offset:36928
ds_add_rtn_u32 v74, v87, v76 offset:26688
s_mov_b64 exec, s[66:67]
buffer_load_dwordx2 v[66:67], v50, s[28:31], 0 offen
s_mov_b64 exec, s[62:63]
v_lshlrev_b32_sdwa v106, 4, v47 dst_sel:DWORD dst_unused:UNUSED_PAD src0_sel:DWORD src1_sel:WORD_0
v_lshlrev_b32_sdwa v105, 3, v47 dst_sel:DWORD dst_unused:UNUSED_PAD src0_sel:DWORD src1_sel:WORD_0
ds_read_b128 v[92:95], v106 offset:0
ds_read_b64 v[96:97], v105 offset:10240
v_lshlrev_b32_sdwa v87, 2, v47 dst_sel:DWORD dst_unused:UNUSED_PAD src0_sel:DWORD src1_sel:WORD_0
s_mov_b64 exec, s[60:61]
v_and_b32 v107, v21, v45
v_mul_f32 v108, v22, v107
v_mul_f32 v109, v23, v107
v_mul_f32 v110, v24, v107
v_fract_f32 v108, v108
v_fract_f32 v109, v109
v_fract_f32 v110, v110
v_cos_f32 v108, v108
v_cos_f32 v109, v109
v_cos_f32 v110, v110
s_waitcnt vmcnt(3)
v_lshlrev_b32 v112, 16, v68
v_and_b32 v113, v21, v68
v_mul_f32 v108, v26, v108
v_mul_f32 v109, v26, v109
v_mul_f32 v110, v26, v110
v_lshlrev_b32 v114, 16, v69
v_and_b32 v115, v21, v69
s_waitcnt lgkmcnt(7)
v_max_u32 v75, v75, v73
v_fma_mix_f32 v116, v108, v80, 0 op_sel:[0,0,0] op_sel_hi:[0,1,0]
v_fma_mix_f32 v117, v108, v80, 0 op_sel:[0,1,0] op_sel_hi:[0,1,0]
v_fma_mix_f32 v118, v108, v81, 0 op_sel:[0,0,0] op_sel_hi:[0,1,0]
v_fma_mix_f32 v119, v108, v81, 0 op_sel:[0,1,0] op_sel_hi:[0,1,0]
v_fma_mix_f32 v116, v109, v82, v116 op_sel:[0,0,0] op_sel_hi:[0,1,0]
v_fma_mix_f32 v117, v109, v82, v117 op_sel:[0,1,0] op_sel_hi:[0,1,0]
v_fma_mix_f32 v118, v109, v83, v118 op_sel:[0,0,0] op_sel_hi:[0,1,0]
v_fma_mix_f32 v119, v109, v83, v119 op_sel:[0,1,0] op_sel_hi:[0,1,0]
v_fma_mix_f32 v116, v110, v84, v116 op_sel:[0,0,0] op_sel_hi:[0,1,0]
v_fma_mix_f32 v117, v110, v84, v117 op_sel:[0,1,0] op_sel_hi:[0,1,0]
v_fma_mix_f32 v118, v110, v85, v118 op_sel:[0,0,0] op_sel_hi:[0,1,0]
v_fma_mix_f32 v119, v110, v85, v119 op_sel:[0,1,0] op_sel_hi:[0,1,0]
v_pk_mul_f32 v[116:117], v[116:117], v[112:113]
v_pk_mul_f32 v[118:119], v[118:119], v[114:115]
v_cvt_rpi_i32_f32 v116, v116
v_cvt_rpi_i32_f32 v117, v117
v_cvt_rpi_i32_f32 v118, v118
v_cvt_rpi_i32_f32 v119, v119
ds_add_u32 v86, v116 offset:29248
ds_add_u32 v86, v117 offset:31808
ds_add_u32 v86, v118 offset:34368
ds_add_u32 v86, v119 offset:36928
ds_add_rtn_u32 v73, v86, v76 offset:26688
s_mov_b64 exec, s[68:69]
buffer_load_dwordx2 v[68:69], v52, s[28:31], 0 offen
s_mov_b64 exec, s[64:65]
v_lshlrev_b32_sdwa v106, 4, v49 dst_sel:DWORD dst_unused:UNUSED_PAD src0_sel:DWORD src1_sel:WORD_0
v_lshlrev_b32_sdwa v104, 3, v49 dst_sel:DWORD dst_unused:UNUSED_PAD src0_sel:DWORD src1_sel:WORD_0
ds_read_b128 v[80:83], v106 offset:0
ds_read_b64 v[84:85], v104 offset:10240
v_lshlrev_b32_sdwa v86, 2, v49 dst_sel:DWORD dst_unused:UNUSED_PAD src0_sel:DWORD src1_sel:WORD_0
s_mov_b64 exec, s[62:63]
v_and_b32 v107, v21, v47
v_mul_f32 v108, v22, v107
v_mul_f32 v109, v23, v107
v_mul_f32 v110, v24, v107
v_fract_f32 v108, v108
v_fract_f32 v109, v109
v_fract_f32 v110, v110
v_cos_f32 v108, v108
v_cos_f32 v109, v109
v_cos_f32 v110, v110
s_waitcnt vmcnt(3)
v_lshlrev_b32 v112, 16, v70
v_and_b32 v113, v21, v70
v_mul_f32 v108, v26, v108
v_mul_f32 v109, v26, v109
v_mul_f32 v110, v26, v110
v_lshlrev_b32 v114, 16, v71
v_and_b32 v115, v21, v71
s_waitcnt lgkmcnt(7)
v_max_u32 v75, v75, v74
v_fma_mix_f32 v116, v108, v92, 0 op_sel:[0,0,0] op_sel_hi:[0,1,0]
v_fma_mix_f32 v117, v108, v92, 0 op_sel:[0,1,0] op_sel_hi:[0,1,0]
v_fma_mix_f32 v118, v108, v93, 0 op_sel:[0,0,0] op_sel_hi:[0,1,0]
v_fma_mix_f32 v119, v108, v93, 0 op_sel:[0,1,0] op_sel_hi:[0,1,0]
v_fma_mix_f32 v116, v109, v94, v116 op_sel:[0,0,0] op_sel_hi:[0,1,0]
v_fma_mix_f32 v117, v109, v94, v117 op_sel:[0,1,0] op_sel_hi:[0,1,0]
v_fma_mix_f32 v118, v109, v95, v118 op_sel:[0,0,0] op_sel_hi:[0,1,0]
v_fma_mix_f32 v119, v109, v95, v119 op_sel:[0,1,0] op_sel_hi:[0,1,0]
v_fma_mix_f32 v116, v110, v96, v116 op_sel:[0,0,0] op_sel_hi:[0,1,0]
v_fma_mix_f32 v117, v110, v96, v117 op_sel:[0,1,0] op_sel_hi:[0,1,0]
v_fma_mix_f32 v118, v110, v97, v118 op_sel:[0,0,0] op_sel_hi:[0,1,0]
v_fma_mix_f32 v119, v110, v97, v119 op_sel:[0,1,0] op_sel_hi:[0,1,0]
v_pk_mul_f32 v[116:117], v[116:117], v[112:113]
v_pk_mul_f32 v[118:119], v[118:119], v[114:115]
v_cvt_rpi_i32_f32 v116, v116
v_cvt_rpi_i32_f32 v117, v117
v_cvt_rpi_i32_f32 v118, v118
v_cvt_rpi_i32_f32 v119, v119
ds_add_u32 v87, v116 offset:29248
ds_add_u32 v87, v117 offset:31808
ds_add_u32 v87, v118 offset:34368
ds_add_u32 v87, v119 offset:36928
ds_add_rtn_u32 v74, v87, v76 offset:26688
s_mov_b64 exec, s[70:71]
buffer_load_dwordx2 v[70:71], v54, s[28:31], 0 offen
s_mov_b64 exec, s[66:67]
v_lshlrev_b32_sdwa v106, 4, v51 dst_sel:DWORD dst_unused:UNUSED_PAD src0_sel:DWORD src1_sel:WORD_0
v_lshlrev_b32_sdwa v105, 3, v51 dst_sel:DWORD dst_unused:UNUSED_PAD src0_sel:DWORD src1_sel:WORD_0
ds_read_b128 v[92:95], v106 offset:0
ds_read_b64 v[96:97], v105 offset:10240
v_lshlrev_b32_sdwa v87, 2, v51 dst_sel:DWORD dst_unused:UNUSED_PAD src0_sel:DWORD src1_sel:WORD_0
s_mov_b64 exec, s[64:65]
v_and_b32 v107, v21, v49
v_mul_f32 v108, v22, v107
v_mul_f32 v109, v23, v107
v_mul_f32 v110, v24, v107
v_fract_f32 v108, v108
v_fract_f32 v109, v109
v_fract_f32 v110, v110
v_cos_f32 v108, v108
v_cos_f32 v109, v109
v_cos_f32 v110, v110
s_waitcnt vmcnt(3)
v_lshlrev_b32 v112, 16, v64
v_and_b32 v113, v21, v64
v_mul_f32 v108, v26, v108
v_mul_f32 v109, v26, v109
v_mul_f32 v110, v26, v110
v_lshlrev_b32 v114, 16, v65
v_and_b32 v115, v21, v65
s_waitcnt lgkmcnt(7)
v_max_u32 v75, v75, v73
v_fma_mix_f32 v116, v108, v80, 0 op_sel:[0,0,0] op_sel_hi:[0,1,0]
v_fma_mix_f32 v117, v108, v80, 0 op_sel:[0,1,0] op_sel_hi:[0,1,0]
v_fma_mix_f32 v118, v108, v81, 0 op_sel:[0,0,0] op_sel_hi:[0,1,0]
v_fma_mix_f32 v119, v108, v81, 0 op_sel:[0,1,0] op_sel_hi:[0,1,0]
v_fma_mix_f32 v116, v109, v82, v116 op_sel:[0,0,0] op_sel_hi:[0,1,0]
v_fma_mix_f32 v117, v109, v82, v117 op_sel:[0,1,0] op_sel_hi:[0,1,0]
v_fma_mix_f32 v118, v109, v83, v118 op_sel:[0,0,0] op_sel_hi:[0,1,0]
v_fma_mix_f32 v119, v109, v83, v119 op_sel:[0,1,0] op_sel_hi:[0,1,0]
v_fma_mix_f32 v116, v110, v84, v116 op_sel:[0,0,0] op_sel_hi:[0,1,0]
v_fma_mix_f32 v117, v110, v84, v117 op_sel:[0,1,0] op_sel_hi:[0,1,0]
v_fma_mix_f32 v118, v110, v85, v118 op_sel:[0,0,0] op_sel_hi:[0,1,0]
v_fma_mix_f32 v119, v110, v85, v119 op_sel:[0,1,0] op_sel_hi:[0,1,0]
v_pk_mul_f32 v[116:117], v[116:117], v[112:113]
v_pk_mul_f32 v[118:119], v[118:119], v[114:115]
v_cvt_rpi_i32_f32 v116, v116
v_cvt_rpi_i32_f32 v117, v117
v_cvt_rpi_i32_f32 v118, v118
v_cvt_rpi_i32_f32 v119, v119
ds_add_u32 v86, v116 offset:29248
ds_add_u32 v86, v117 offset:31808
ds_add_u32 v86, v118 offset:34368
ds_add_u32 v86, v119 offset:36928
ds_add_rtn_u32 v73, v86, v76 offset:26688
s_mov_b64 exec, s[72:73]
buffer_load_dwordx2 v[64:65], v56, s[28:31], 0 offen
s_mov_b64 exec, s[68:69]
v_lshlrev_b32_sdwa v106, 4, v53 dst_sel:DWORD dst_unused:UNUSED_PAD src0_sel:DWORD src1_sel:WORD_0
v_lshlrev_b32_sdwa v104, 3, v53 dst_sel:DWORD dst_unused:UNUSED_PAD src0_sel:DWORD src1_sel:WORD_0
ds_read_b128 v[80:83], v106 offset:0
ds_read_b64 v[84:85], v104 offset:10240
v_lshlrev_b32_sdwa v86, 2, v53 dst_sel:DWORD dst_unused:UNUSED_PAD src0_sel:DWORD src1_sel:WORD_0
s_mov_b64 exec, s[66:67]
v_and_b32 v107, v21, v51
v_mul_f32 v108, v22, v107
v_mul_f32 v109, v23, v107
v_mul_f32 v110, v24, v107
v_fract_f32 v108, v108
v_fract_f32 v109, v109
v_fract_f32 v110, v110
v_cos_f32 v108, v108
v_cos_f32 v109, v109
v_cos_f32 v110, v110
s_waitcnt vmcnt(3)
v_lshlrev_b32 v112, 16, v66
v_and_b32 v113, v21, v66
v_mul_f32 v108, v26, v108
v_mul_f32 v109, v26, v109
v_mul_f32 v110, v26, v110
v_lshlrev_b32 v114, 16, v67
v_and_b32 v115, v21, v67
s_waitcnt lgkmcnt(7)
v_max_u32 v75, v75, v74
v_fma_mix_f32 v116, v108, v92, 0 op_sel:[0,0,0] op_sel_hi:[0,1,0]
v_fma_mix_f32 v117, v108, v92, 0 op_sel:[0,1,0] op_sel_hi:[0,1,0]
v_fma_mix_f32 v118, v108, v93, 0 op_sel:[0,0,0] op_sel_hi:[0,1,0]
v_fma_mix_f32 v119, v108, v93, 0 op_sel:[0,1,0] op_sel_hi:[0,1,0]
v_fma_mix_f32 v116, v109, v94, v116 op_sel:[0,0,0] op_sel_hi:[0,1,0]
v_fma_mix_f32 v117, v109, v94, v117 op_sel:[0,1,0] op_sel_hi:[0,1,0]
v_fma_mix_f32 v118, v109, v95, v118 op_sel:[0,0,0] op_sel_hi:[0,1,0]
v_fma_mix_f32 v119, v109, v95, v119 op_sel:[0,1,0] op_sel_hi:[0,1,0]
v_fma_mix_f32 v116, v110, v96, v116 op_sel:[0,0,0] op_sel_hi:[0,1,0]
v_fma_mix_f32 v117, v110, v96, v117 op_sel:[0,1,0] op_sel_hi:[0,1,0]
v_fma_mix_f32 v118, v110, v97, v118 op_sel:[0,0,0] op_sel_hi:[0,1,0]
v_fma_mix_f32 v119, v110, v97, v119 op_sel:[0,1,0] op_sel_hi:[0,1,0]
v_pk_mul_f32 v[116:117], v[116:117], v[112:113]
v_pk_mul_f32 v[118:119], v[118:119], v[114:115]
v_cvt_rpi_i32_f32 v116, v116
v_cvt_rpi_i32_f32 v117, v117
v_cvt_rpi_i32_f32 v118, v118
v_cvt_rpi_i32_f32 v119, v119
ds_add_u32 v87, v116 offset:29248
ds_add_u32 v87, v117 offset:31808
ds_add_u32 v87, v118 offset:34368
ds_add_u32 v87, v119 offset:36928
ds_add_rtn_u32 v74, v87, v76 offset:26688
s_mov_b64 exec, s[74:75]
buffer_load_dwordx2 v[66:67], v58, s[28:31], 0 offen
s_mov_b64 exec, s[70:71]
v_lshlrev_b32_sdwa v106, 4, v55 dst_sel:DWORD dst_unused:UNUSED_PAD src0_sel:DWORD src1_sel:WORD_0
v_lshlrev_b32_sdwa v105, 3, v55 dst_sel:DWORD dst_unused:UNUSED_PAD src0_sel:DWORD src1_sel:WORD_0
ds_read_b128 v[92:95], v106 offset:0
ds_read_b64 v[96:97], v105 offset:10240
v_lshlrev_b32_sdwa v87, 2, v55 dst_sel:DWORD dst_unused:UNUSED_PAD src0_sel:DWORD src1_sel:WORD_0
s_mov_b64 exec, s[68:69]
v_and_b32 v107, v21, v53
v_mul_f32 v108, v22, v107
v_mul_f32 v109, v23, v107
v_mul_f32 v110, v24, v107
v_fract_f32 v108, v108
v_fract_f32 v109, v109
v_fract_f32 v110, v110
v_cos_f32 v108, v108
v_cos_f32 v109, v109
v_cos_f32 v110, v110
s_waitcnt vmcnt(3)
v_lshlrev_b32 v112, 16, v68
v_and_b32 v113, v21, v68
v_mul_f32 v108, v26, v108
v_mul_f32 v109, v26, v109
v_mul_f32 v110, v26, v110
v_lshlrev_b32 v114, 16, v69
v_and_b32 v115, v21, v69
s_waitcnt lgkmcnt(7)
v_max_u32 v75, v75, v73
v_fma_mix_f32 v116, v108, v80, 0 op_sel:[0,0,0] op_sel_hi:[0,1,0]
v_fma_mix_f32 v117, v108, v80, 0 op_sel:[0,1,0] op_sel_hi:[0,1,0]
v_fma_mix_f32 v118, v108, v81, 0 op_sel:[0,0,0] op_sel_hi:[0,1,0]
v_fma_mix_f32 v119, v108, v81, 0 op_sel:[0,1,0] op_sel_hi:[0,1,0]
v_fma_mix_f32 v116, v109, v82, v116 op_sel:[0,0,0] op_sel_hi:[0,1,0]
v_fma_mix_f32 v117, v109, v82, v117 op_sel:[0,1,0] op_sel_hi:[0,1,0]
v_fma_mix_f32 v118, v109, v83, v118 op_sel:[0,0,0] op_sel_hi:[0,1,0]
v_fma_mix_f32 v119, v109, v83, v119 op_sel:[0,1,0] op_sel_hi:[0,1,0]
v_fma_mix_f32 v116, v110, v84, v116 op_sel:[0,0,0] op_sel_hi:[0,1,0]
v_fma_mix_f32 v117, v110, v84, v117 op_sel:[0,1,0] op_sel_hi:[0,1,0]
v_fma_mix_f32 v118, v110, v85, v118 op_sel:[0,0,0] op_sel_hi:[0,1,0]
v_fma_mix_f32 v119, v110, v85, v119 op_sel:[0,1,0] op_sel_hi:[0,1,0]
v_pk_mul_f32 v[116:117], v[116:117], v[112:113]
v_pk_mul_f32 v[118:119], v[118:119], v[114:115]
v_cvt_rpi_i32_f32 v116, v116
v_cvt_rpi_i32_f32 v117, v117
v_cvt_rpi_i32_f32 v118, v118
v_cvt_rpi_i32_f32 v119, v119
ds_add_u32 v86, v116 offset:29248
ds_add_u32 v86, v117 offset:31808
ds_add_u32 v86, v118 offset:34368
ds_add_u32 v86, v119 offset:36928
ds_add_rtn_u32 v73, v86, v76 offset:26688
s_mov_b64 exec, s[72:73]
v_lshlrev_b32_sdwa v106, 4, v57 dst_sel:DWORD dst_unused:UNUSED_PAD src0_sel:DWORD src1_sel:WORD_0
v_lshlrev_b32_sdwa v104, 3, v57 dst_sel:DWORD dst_unused:UNUSED_PAD src0_sel:DWORD src1_sel:WORD_0
ds_read_b128 v[80:83], v106 offset:0
ds_read_b64 v[84:85], v104 offset:10240
v_lshlrev_b32_sdwa v86, 2, v57 dst_sel:DWORD dst_unused:UNUSED_PAD src0_sel:DWORD src1_sel:WORD_0
s_mov_b64 exec, s[70:71]
v_and_b32 v107, v21, v55
v_mul_f32 v108, v22, v107
v_mul_f32 v109, v23, v107
v_mul_f32 v110, v24, v107
v_fract_f32 v108, v108
v_fract_f32 v109, v109
v_fract_f32 v110, v110
v_cos_f32 v108, v108
v_cos_f32 v109, v109
v_cos_f32 v110, v110
s_waitcnt vmcnt(2)
v_lshlrev_b32 v112, 16, v70
v_and_b32 v113, v21, v70
v_mul_f32 v108, v26, v108
v_mul_f32 v109, v26, v109
v_mul_f32 v110, v26, v110
v_lshlrev_b32 v114, 16, v71
v_and_b32 v115, v21, v71
s_waitcnt lgkmcnt(7)
v_max_u32 v75, v75, v74
v_fma_mix_f32 v116, v108, v92, 0 op_sel:[0,0,0] op_sel_hi:[0,1,0]
v_fma_mix_f32 v117, v108, v92, 0 op_sel:[0,1,0] op_sel_hi:[0,1,0]
v_fma_mix_f32 v118, v108, v93, 0 op_sel:[0,0,0] op_sel_hi:[0,1,0]
v_fma_mix_f32 v119, v108, v93, 0 op_sel:[0,1,0] op_sel_hi:[0,1,0]
v_fma_mix_f32 v116, v109, v94, v116 op_sel:[0,0,0] op_sel_hi:[0,1,0]
v_fma_mix_f32 v117, v109, v94, v117 op_sel:[0,1,0] op_sel_hi:[0,1,0]
v_fma_mix_f32 v118, v109, v95, v118 op_sel:[0,0,0] op_sel_hi:[0,1,0]
v_fma_mix_f32 v119, v109, v95, v119 op_sel:[0,1,0] op_sel_hi:[0,1,0]
v_fma_mix_f32 v116, v110, v96, v116 op_sel:[0,0,0] op_sel_hi:[0,1,0]
v_fma_mix_f32 v117, v110, v96, v117 op_sel:[0,1,0] op_sel_hi:[0,1,0]
v_fma_mix_f32 v118, v110, v97, v118 op_sel:[0,0,0] op_sel_hi:[0,1,0]
v_fma_mix_f32 v119, v110, v97, v119 op_sel:[0,1,0] op_sel_hi:[0,1,0]
v_pk_mul_f32 v[116:117], v[116:117], v[112:113]
v_pk_mul_f32 v[118:119], v[118:119], v[114:115]
v_cvt_rpi_i32_f32 v116, v116
v_cvt_rpi_i32_f32 v117, v117
v_cvt_rpi_i32_f32 v118, v118
v_cvt_rpi_i32_f32 v119, v119
ds_add_u32 v87, v116 offset:29248
ds_add_u32 v87, v117 offset:31808
ds_add_u32 v87, v118 offset:34368
ds_add_u32 v87, v119 offset:36928
ds_add_rtn_u32 v74, v87, v76 offset:26688
s_mov_b64 exec, s[74:75]
v_lshlrev_b32_sdwa v106, 4, v59 dst_sel:DWORD dst_unused:UNUSED_PAD src0_sel:DWORD src1_sel:WORD_0
v_lshlrev_b32_sdwa v105, 3, v59 dst_sel:DWORD dst_unused:UNUSED_PAD src0_sel:DWORD src1_sel:WORD_0
ds_read_b128 v[92:95], v106 offset:0
ds_read_b64 v[96:97], v105 offset:10240
v_lshlrev_b32_sdwa v87, 2, v59 dst_sel:DWORD dst_unused:UNUSED_PAD src0_sel:DWORD src1_sel:WORD_0
s_mov_b64 exec, s[72:73]
v_and_b32 v107, v21, v57
v_mul_f32 v108, v22, v107
v_mul_f32 v109, v23, v107
v_mul_f32 v110, v24, v107
v_fract_f32 v108, v108
v_fract_f32 v109, v109
v_fract_f32 v110, v110
v_cos_f32 v108, v108
v_cos_f32 v109, v109
v_cos_f32 v110, v110
s_waitcnt vmcnt(1)
v_lshlrev_b32 v112, 16, v64
v_and_b32 v113, v21, v64
v_mul_f32 v108, v26, v108
v_mul_f32 v109, v26, v109
v_mul_f32 v110, v26, v110
v_lshlrev_b32 v114, 16, v65
v_and_b32 v115, v21, v65
s_waitcnt lgkmcnt(7)
v_max_u32 v75, v75, v73
v_fma_mix_f32 v116, v108, v80, 0 op_sel:[0,0,0] op_sel_hi:[0,1,0]
v_fma_mix_f32 v117, v108, v80, 0 op_sel:[0,1,0] op_sel_hi:[0,1,0]
v_fma_mix_f32 v118, v108, v81, 0 op_sel:[0,0,0] op_sel_hi:[0,1,0]
v_fma_mix_f32 v119, v108, v81, 0 op_sel:[0,1,0] op_sel_hi:[0,1,0]
v_fma_mix_f32 v116, v109, v82, v116 op_sel:[0,0,0] op_sel_hi:[0,1,0]
v_fma_mix_f32 v117, v109, v82, v117 op_sel:[0,1,0] op_sel_hi:[0,1,0]
v_fma_mix_f32 v118, v109, v83, v118 op_sel:[0,0,0] op_sel_hi:[0,1,0]
v_fma_mix_f32 v119, v109, v83, v119 op_sel:[0,1,0] op_sel_hi:[0,1,0]
v_fma_mix_f32 v116, v110, v84, v116 op_sel:[0,0,0] op_sel_hi:[0,1,0]
v_fma_mix_f32 v117, v110, v84, v117 op_sel:[0,1,0] op_sel_hi:[0,1,0]
v_fma_mix_f32 v118, v110, v85, v118 op_sel:[0,0,0] op_sel_hi:[0,1,0]
v_fma_mix_f32 v119, v110, v85, v119 op_sel:[0,1,0] op_sel_hi:[0,1,0]
v_pk_mul_f32 v[116:117], v[116:117], v[112:113]
v_pk_mul_f32 v[118:119], v[118:119], v[114:115]
v_cvt_rpi_i32_f32 v116, v116
v_cvt_rpi_i32_f32 v117, v117
v_cvt_rpi_i32_f32 v118, v118
v_cvt_rpi_i32_f32 v119, v119
ds_add_u32 v86, v116 offset:29248
ds_add_u32 v86, v117 offset:31808
ds_add_u32 v86, v118 offset:34368
ds_add_u32 v86, v119 offset:36928
ds_add_rtn_u32 v73, v86, v76 offset:26688
s_mov_b64 exec, s[74:75]
v_and_b32 v107, v21, v59
v_mul_f32 v108, v22, v107
v_mul_f32 v109, v23, v107
v_mul_f32 v110, v24, v107
v_fract_f32 v108, v108
v_fract_f32 v109, v109
v_fract_f32 v110, v110
v_cos_f32 v108, v108
v_cos_f32 v109, v109
v_cos_f32 v110, v110
s_waitcnt vmcnt(0)
v_lshlrev_b32 v112, 16, v66
v_and_b32 v113, v21, v66
v_mul_f32 v108, v26, v108
v_mul_f32 v109, v26, v109
v_mul_f32 v110, v26, v110
v_lshlrev_b32 v114, 16, v67
v_and_b32 v115, v21, v67
s_waitcnt lgkmcnt(5)
v_max_u32 v75, v75, v74
v_fma_mix_f32 v116, v108, v92, 0 op_sel:[0,0,0] op_sel_hi:[0,1,0]
v_fma_mix_f32 v117, v108, v92, 0 op_sel:[0,1,0] op_sel_hi:[0,1,0]
v_fma_mix_f32 v118, v108, v93, 0 op_sel:[0,0,0] op_sel_hi:[0,1,0]
v_fma_mix_f32 v119, v108, v93, 0 op_sel:[0,1,0] op_sel_hi:[0,1,0]
v_fma_mix_f32 v116, v109, v94, v116 op_sel:[0,0,0] op_sel_hi:[0,1,0]
v_fma_mix_f32 v117, v109, v94, v117 op_sel:[0,1,0] op_sel_hi:[0,1,0]
v_fma_mix_f32 v118, v109, v95, v118 op_sel:[0,0,0] op_sel_hi:[0,1,0]
v_fma_mix_f32 v119, v109, v95, v119 op_sel:[0,1,0] op_sel_hi:[0,1,0]
v_fma_mix_f32 v116, v110, v96, v116 op_sel:[0,0,0] op_sel_hi:[0,1,0]
v_fma_mix_f32 v117, v110, v96, v117 op_sel:[0,1,0] op_sel_hi:[0,1,0]
v_fma_mix_f32 v118, v110, v97, v118 op_sel:[0,0,0] op_sel_hi:[0,1,0]
v_fma_mix_f32 v119, v110, v97, v119 op_sel:[0,1,0] op_sel_hi:[0,1,0]
v_pk_mul_f32 v[116:117], v[116:117], v[112:113]
v_pk_mul_f32 v[118:119], v[118:119], v[114:115]
v_cvt_rpi_i32_f32 v116, v116
v_cvt_rpi_i32_f32 v117, v117
v_cvt_rpi_i32_f32 v118, v118
v_cvt_rpi_i32_f32 v119, v119
ds_add_u32 v87, v116 offset:29248
ds_add_u32 v87, v117 offset:31808
ds_add_u32 v87, v118 offset:34368
ds_add_u32 v87, v119 offset:36928
ds_add_rtn_u32 v74, v87, v76 offset:26688
s_mov_b64 exec, -1
s_cmp_lg_u32 s23, 0
s_cbranch_scc1 acc_wide
acc_wide_back:
s_cmp_lg_u32 s11, 0
s_cbranch_scc1 acc_extra
acc_x3:
s_mov_b64 exec, -1
s_waitcnt lgkmcnt(0)
v_max3_u32 v75, v75, v73, v74
v_cmp_le_u32 vcc, 64, v75
s_cmp_eq_u64 vcc, 0
s_cbranch_scc1 acc_noflag
v_mov_b32 v8, 25608
v_mov_b32 v9, 1
ds_write_b32 v8, v9
acc_noflag:
s_waitcnt vmcnt(0) lgkmcnt(0)
s_barrier
ds_read_b32 v8, v79
ds_read_b32 v12, v102 offset:29248
ds_read_b32 v13, v102 offset:31808
ds_read_b32 v14, v102 offset:34368
ds_read_b32 v15, v102 offset:36928
s_waitcnt lgkmcnt(0)
v_readfirstlane_b32 s36, v8
s_andn2_b32 s36, s36, s42
s_cmp_lg_u32 s36, 0
s_cbranch_scc1 acc_redo
s_cmp_lt_u32 s22, 10
s_cbranch_scc0 acc_fin_done
s_mov_b32 s36, s18
s_and_b32 s37, s19, 0xffff
s_mov_b32 s38, 1280000
s_mov_b32 s39, 0x20000
v_cmp_gt_u32 vcc, 625, v0
s_and_saveexec_b64 s[98:99], vcc
v_cvt_f32_i32 v12, v12
v_cvt_f32_i32 v13, v13
v_cvt_f32_i32 v14, v14
v_cvt_f32_i32 v15, v15
v_ldexp_f32 v12, v12, v98
v_ldexp_f32 v13, v13, v99
v_ldexp_f32 v14, v14, v100
v_ldexp_f32 v15, v15, v101
v_mul_f32 v64, s80, v12
v_fmac_f32 v64, s84, v13
v_fmac_f32 v64, s88, v14
v_fmac_f32 v64, s92, v15
v_mul_f32 v65, s81, v12
v_fmac_f32 v65, s85, v13
v_fmac_f32 v65, s89, v14
v_fmac_f32 v65, s93, v15
v_mul_f32 v66, s82, v12
v_fmac_f32 v66, s86, v13
v_fmac_f32 v66, s90, v14
v_fmac_f32 v66, s94, v15
v_mul_f32 v67, s83, v12
v_fmac_f32 v67, s87, v13
v_fmac_f32 v67, s91, v14
v_fmac_f32 v67, s95, v15
v_fmac_f32 v88, v64, v16
v_fmac_f32 v89, v65, v17
v_fmac_f32 v90, v66, v18
v_fmac_f32 v91, v67, v19
v_cvt_pk_bf16_f32 v32, v88, v89
v_cvt_pk_bf16_f32 v33, v90, v91
buffer_store_dwordx2 v[32:33], v77, s[36:39], 0 offen
s_mov_b64 exec, -1
acc_fin_done:
acc_end:
s_endpgm
acc_retry_0:
s_mov_b64 s[96:97], vcc
s_andn2_b64 exec, exec, vcc
ds_write_b64 v12, v[64:65]
s_mov_b64 exec, s[96:97]
s_mov_b32 s98, 12
acc_retry_loop_0:
v_add_u32 v8, 4, v8
v_cmp_le_u32 vcc, 896, v8
v_subrev_u32 v16, 896, v8
s_nop 0
v_cndmask_b32 v8, v8, v16, vcc
ds_add_rtn_u32 v12, v8, v26 offset:25664
v_mad_u32_u24 v73, v8, v77, s37
s_waitcnt lgkmcnt(0)
v_cmp_ge_u32 vcc, v12, v73
s_mov_b64 s[96:97], vcc
s_andn2_b64 exec, exec, vcc
ds_write_b64 v12, v[64:65]
s_mov_b64 exec, s[96:97]
s_cbranch_execz acc_retry_back_0
s_sub_u32 s98, s98, 1
s_cmp_lg_u32 s98, 0
s_cbranch_scc1 acc_retry_loop_0
s_mov_b64 s[48:49], exec
s_bitset1_b32 s23, 0
s_branch acc_retry_back_0
acc_retry_1:
s_mov_b64 s[96:97], vcc
s_andn2_b64 exec, exec, vcc
ds_write_b64 v13, v[66:67]
s_mov_b64 exec, s[96:97]
s_mov_b32 s98, 12
acc_retry_loop_1:
v_add_u32 v9, 4, v9
v_cmp_le_u32 vcc, 896, v9
v_subrev_u32 v16, 896, v9
s_nop 0
v_cndmask_b32 v9, v9, v16, vcc
ds_add_rtn_u32 v13, v9, v26 offset:25664
v_mad_u32_u24 v74, v9, v77, s37
s_waitcnt lgkmcnt(0)
v_cmp_ge_u32 vcc, v13, v74
s_mov_b64 s[96:97], vcc
s_andn2_b64 exec, exec, vcc
ds_write_b64 v13, v[66:67]
s_mov_b64 exec, s[96:97]
s_cbranch_execz acc_retry_back_1
s_sub_u32 s98, s98, 1
s_cmp_lg_u32 s98, 0
s_cbranch_scc1 acc_retry_loop_1
s_mov_b64 s[50:51], exec
s_bitset1_b32 s23, 1
s_branch acc_retry_back_1
acc_retry_2:
s_mov_b64 s[96:97], vcc
s_andn2_b64 exec, exec, vcc
ds_write_b64 v14, v[68:69]
s_mov_b64 exec, s[96:97]
s_mov_b32 s98, 12
acc_retry_loop_2:
v_add_u32 v10, 4, v10
v_cmp_le_u32 vcc, 896, v10
v_subrev_u32 v16, 896, v10
s_nop 0
v_cndmask_b32 v10, v10, v16, vcc
ds_add_rtn_u32 v14, v10, v26 offset:25664
v_mad_u32_u24 v75, v10, v77, s37
s_waitcnt lgkmcnt(0)
v_cmp_ge_u32 vcc, v14, v75
s_mov_b64 s[96:97], vcc
s_andn2_b64 exec, exec, vcc
ds_write_b64 v14, v[68:69]
s_mov_b64 exec, s[96:97]
s_cbranch_execz acc_retry_back_2
s_sub_u32 s98, s98, 1
s_cmp_lg_u32 s98, 0
s_cbranch_scc1 acc_retry_loop_2
s_mov_b64 s[52:53], exec
s_bitset1_b32 s23, 2
s_branch acc_retry_back_2
acc_retry_3:
s_mov_b64 s[96:97], vcc
s_andn2_b64 exec, exec, vcc
ds_write_b64 v15, v[70:71]
s_mov_b64 exec, s[96:97]
s_mov_b32 s98, 12
acc_retry_loop_3:
v_add_u32 v11, 4, v11
v_cmp_le_u32 vcc, 896, v11
v_subrev_u32 v16, 896, v11
s_nop 0
v_cndmask_b32 v11, v11, v16, vcc
ds_add_rtn_u32 v15, v11, v26 offset:25664
v_mad_u32_u24 v76, v11, v77, s37
s_waitcnt lgkmcnt(0)
v_cmp_ge_u32 vcc, v15, v76
s_mov_b64 s[96:97], vcc
s_andn2_b64 exec, exec, vcc
ds_write_b64 v15, v[70:71]
s_mov_b64 exec, s[96:97]
s_cbranch_execz acc_retry_back_3
s_sub_u32 s98, s98, 1
s_cmp_lg_u32 s98, 0
s_cbranch_scc1 acc_retry_loop_3
s_mov_b64 s[54:55], exec
s_bitset1_b32 s23, 3
s_branch acc_retry_back_3
acc_retry_4:
s_mov_b64 s[96:97], vcc
s_andn2_b64 exec, exec, vcc
ds_write_b64 v12, v[64:65]
s_mov_b64 exec, s[96:97]
s_mov_b32 s98, 12
acc_retry_loop_4:
v_add_u32 v8, 4, v8
v_cmp_le_u32 vcc, 896, v8
v_subrev_u32 v16, 896, v8
s_nop 0
v_cndmask_b32 v8, v8, v16, vcc
ds_add_rtn_u32 v12, v8, v26 offset:25664
v_mad_u32_u24 v73, v8, v77, s37
s_waitcnt lgkmcnt(0)
v_cmp_ge_u32 vcc, v12, v73
s_mov_b64 s[96:97], vcc
s_andn2_b64 exec, exec, vcc
ds_write_b64 v12, v[64:65]
s_mov_b64 exec, s[96:97]
s_cbranch_execz acc_retry_back_4
s_sub_u32 s98, s98, 1
s_cmp_lg_u32 s98, 0
s_cbranch_scc1 acc_retry_loop_4
s_mov_b64 s[56:57], exec
s_bitset1_b32 s23, 4
s_branch acc_retry_back_4
acc_retry_5:
s_mov_b64 s[96:97], vcc
s_andn2_b64 exec, exec, vcc
ds_write_b64 v13, v[66:67]
s_mov_b64 exec, s[96:97]
s_mov_b32 s98, 12
acc_retry_loop_5:
v_add_u32 v9, 4, v9
v_cmp_le_u32 vcc, 896, v9
v_subrev_u32 v16, 896, v9
s_nop 0
v_cndmask_b32 v9, v9, v16, vcc
ds_add_rtn_u32 v13, v9, v26 offset:25664
v_mad_u32_u24 v74, v9, v77, s37
s_waitcnt lgkmcnt(0)
v_cmp_ge_u32 vcc, v13, v74
s_mov_b64 s[96:97], vcc
s_andn2_b64 exec, exec, vcc
ds_write_b64 v13, v[66:67]
s_mov_b64 exec, s[96:97]
s_cbranch_execz acc_retry_back_5
s_sub_u32 s98, s98, 1
s_cmp_lg_u32 s98, 0
s_cbranch_scc1 acc_retry_loop_5
s_mov_b64 s[58:59], exec
s_bitset1_b32 s23, 5
s_branch acc_retry_back_5
acc_retry_6:
s_mov_b64 s[96:97], vcc
s_andn2_b64 exec, exec, vcc
ds_write_b64 v14, v[68:69]
s_mov_b64 exec, s[96:97]
s_mov_b32 s98, 12
acc_retry_loop_6:
v_add_u32 v10, 4, v10
v_cmp_le_u32 vcc, 896, v10
v_subrev_u32 v16, 896, v10
s_nop 0
v_cndmask_b32 v10, v10, v16, vcc
ds_add_rtn_u32 v14, v10, v26 offset:25664
v_mad_u32_u24 v75, v10, v77, s37
s_waitcnt lgkmcnt(0)
v_cmp_ge_u32 vcc, v14, v75
s_mov_b64 s[96:97], vcc
s_andn2_b64 exec, exec, vcc
ds_write_b64 v14, v[68:69]
s_mov_b64 exec, s[96:97]
s_cbranch_execz acc_retry_back_6
s_sub_u32 s98, s98, 1
s_cmp_lg_u32 s98, 0
s_cbranch_scc1 acc_retry_loop_6
s_mov_b64 s[60:61], exec
s_bitset1_b32 s23, 6
s_branch acc_retry_back_6
acc_retry_7:
s_mov_b64 s[96:97], vcc
s_andn2_b64 exec, exec, vcc
ds_write_b64 v15, v[70:71]
s_mov_b64 exec, s[96:97]
s_mov_b32 s98, 12
acc_retry_loop_7:
v_add_u32 v11, 4, v11
v_cmp_le_u32 vcc, 896, v11
v_subrev_u32 v16, 896, v11
s_nop 0
v_cndmask_b32 v11, v11, v16, vcc
ds_add_rtn_u32 v15, v11, v26 offset:25664
v_mad_u32_u24 v76, v11, v77, s37
s_waitcnt lgkmcnt(0)
v_cmp_ge_u32 vcc, v15, v76
s_mov_b64 s[96:97], vcc
s_andn2_b64 exec, exec, vcc
ds_write_b64 v15, v[70:71]
s_mov_b64 exec, s[96:97]
s_cbranch_execz acc_retry_back_7
s_sub_u32 s98, s98, 1
s_cmp_lg_u32 s98, 0
s_cbranch_scc1 acc_retry_loop_7
s_mov_b64 s[62:63], exec
s_bitset1_b32 s23, 7
s_branch acc_retry_back_7
acc_retry_8:
s_mov_b64 s[96:97], vcc
s_andn2_b64 exec, exec, vcc
ds_write_b64 v12, v[64:65]
s_mov_b64 exec, s[96:97]
s_mov_b32 s98, 12
acc_retry_loop_8:
v_add_u32 v8, 4, v8
v_cmp_le_u32 vcc, 896, v8
v_subrev_u32 v16, 896, v8
s_nop 0
v_cndmask_b32 v8, v8, v16, vcc
ds_add_rtn_u32 v12, v8, v26 offset:25664
v_mad_u32_u24 v73, v8, v77, s37
s_waitcnt lgkmcnt(0)
v_cmp_ge_u32 vcc, v12, v73
s_mov_b64 s[96:97], vcc
s_andn2_b64 exec, exec, vcc
ds_write_b64 v12, v[64:65]
s_mov_b64 exec, s[96:97]
s_cbranch_execz acc_retry_back_8
s_sub_u32 s98, s98, 1
s_cmp_lg_u32 s98, 0
s_cbranch_scc1 acc_retry_loop_8
s_mov_b64 s[64:65], exec
s_bitset1_b32 s23, 8
s_branch acc_retry_back_8
acc_retry_9:
s_mov_b64 s[96:97], vcc
s_andn2_b64 exec, exec, vcc
ds_write_b64 v13, v[66:67]
s_mov_b64 exec, s[96:97]
s_mov_b32 s98, 12
acc_retry_loop_9:
v_add_u32 v9, 4, v9
v_cmp_le_u32 vcc, 896, v9
v_subrev_u32 v16, 896, v9
s_nop 0
v_cndmask_b32 v9, v9, v16, vcc
ds_add_rtn_u32 v13, v9, v26 offset:25664
v_mad_u32_u24 v74, v9, v77, s37
s_waitcnt lgkmcnt(0)
v_cmp_ge_u32 vcc, v13, v74
s_mov_b64 s[96:97], vcc
s_andn2_b64 exec, exec, vcc
ds_write_b64 v13, v[66:67]
s_mov_b64 exec, s[96:97]
s_cbranch_execz acc_retry_back_9
s_sub_u32 s98, s98, 1
s_cmp_lg_u32 s98, 0
s_cbranch_scc1 acc_retry_loop_9
s_mov_b64 s[66:67], exec
s_bitset1_b32 s23, 9
s_branch acc_retry_back_9
acc_retry_10:
s_mov_b64 s[96:97], vcc
s_andn2_b64 exec, exec, vcc
ds_write_b64 v14, v[68:69]
s_mov_b64 exec, s[96:97]
s_mov_b32 s98, 12
acc_retry_loop_10:
v_add_u32 v10, 4, v10
v_cmp_le_u32 vcc, 896, v10
v_subrev_u32 v16, 896, v10
s_nop 0
v_cndmask_b32 v10, v10, v16, vcc
ds_add_rtn_u32 v14, v10, v26 offset:25664
v_mad_u32_u24 v75, v10, v77, s37
s_waitcnt lgkmcnt(0)
v_cmp_ge_u32 vcc, v14, v75
s_mov_b64 s[96:97], vcc
s_andn2_b64 exec, exec, vcc
ds_write_b64 v14, v[68:69]
s_mov_b64 exec, s[96:97]
s_cbranch_execz acc_retry_back_10
s_sub_u32 s98, s98, 1
s_cmp_lg_u32 s98, 0
s_cbranch_scc1 acc_retry_loop_10
s_mov_b64 s[68:69], exec
s_bitset1_b32 s23, 10
s_branch acc_retry_back_10
acc_retry_11:
s_mov_b64 s[96:97], vcc
s_andn2_b64 exec, exec, vcc
ds_write_b64 v15, v[70:71]
s_mov_b64 exec, s[96:97]
s_mov_b32 s98, 12
acc_retry_loop_11:
v_add_u32 v11, 4, v11
v_cmp_le_u32 vcc, 896, v11
v_subrev_u32 v16, 896, v11
s_nop 0
v_cndmask_b32 v11, v11, v16, vcc
ds_add_rtn_u32 v15, v11, v26 offset:25664
v_mad_u32_u24 v76, v11, v77, s37
s_waitcnt lgkmcnt(0)
v_cmp_ge_u32 vcc, v15, v76
s_mov_b64 s[96:97], vcc
s_andn2_b64 exec, exec, vcc
ds_write_b64 v15, v[70:71]
s_mov_b64 exec, s[96:97]
s_cbranch_execz acc_retry_back_11
s_sub_u32 s98, s98, 1
s_cmp_lg_u32 s98, 0
s_cbranch_scc1 acc_retry_loop_11
s_mov_b64 s[70:71], exec
s_bitset1_b32 s23, 11
s_branch acc_retry_back_11
acc_retry_12:
s_mov_b64 s[96:97], vcc
s_andn2_b64 exec, exec, vcc
ds_write_b64 v12, v[64:65]
s_mov_b64 exec, s[96:97]
s_mov_b32 s98, 12
acc_retry_loop_12:
v_add_u32 v8, 4, v8
v_cmp_le_u32 vcc, 896, v8
v_subrev_u32 v16, 896, v8
s_nop 0
v_cndmask_b32 v8, v8, v16, vcc
ds_add_rtn_u32 v12, v8, v26 offset:25664
v_mad_u32_u24 v73, v8, v77, s37
s_waitcnt lgkmcnt(0)
v_cmp_ge_u32 vcc, v12, v73
s_mov_b64 s[96:97], vcc
s_andn2_b64 exec, exec, vcc
ds_write_b64 v12, v[64:65]
s_mov_b64 exec, s[96:97]
s_cbranch_execz acc_retry_back_12
s_sub_u32 s98, s98, 1
s_cmp_lg_u32 s98, 0
s_cbranch_scc1 acc_retry_loop_12
s_mov_b64 s[72:73], exec
s_bitset1_b32 s23, 12
s_branch acc_retry_back_12
acc_retry_13:
s_mov_b64 s[96:97], vcc
s_andn2_b64 exec, exec, vcc
ds_write_b64 v13, v[66:67]
s_mov_b64 exec, s[96:97]
s_mov_b32 s98, 12
acc_retry_loop_13:
v_add_u32 v9, 4, v9
v_cmp_le_u32 vcc, 896, v9
v_subrev_u32 v16, 896, v9
s_nop 0
v_cndmask_b32 v9, v9, v16, vcc
ds_add_rtn_u32 v13, v9, v26 offset:25664
v_mad_u32_u24 v74, v9, v77, s37
s_waitcnt lgkmcnt(0)
v_cmp_ge_u32 vcc, v13, v74
s_mov_b64 s[96:97], vcc
s_andn2_b64 exec, exec, vcc
ds_write_b64 v13, v[66:67]
s_mov_b64 exec, s[96:97]
s_cbranch_execz acc_retry_back_13
s_sub_u32 s98, s98, 1
s_cmp_lg_u32 s98, 0
s_cbranch_scc1 acc_retry_loop_13
s_mov_b64 s[74:75], exec
s_bitset1_b32 s23, 13
s_branch acc_retry_back_13
acc_retry_14:
s_mov_b64 s[96:97], vcc
s_andn2_b64 exec, exec, vcc
ds_write_b64 v14, v[68:69]
s_mov_b64 exec, s[96:97]
s_mov_b32 s98, 12
acc_retry_loop_14:
v_add_u32 v10, 4, v10
v_cmp_le_u32 vcc, 896, v10
v_subrev_u32 v16, 896, v10
s_nop 0
v_cndmask_b32 v10, v10, v16, vcc
ds_add_rtn_u32 v14, v10, v26 offset:25664
v_mad_u32_u24 v75, v10, v77, s37
s_waitcnt lgkmcnt(0)
v_cmp_ge_u32 vcc, v14, v75
s_mov_b64 s[96:97], vcc
s_andn2_b64 exec, exec, vcc
ds_write_b64 v14, v[68:69]
s_mov_b64 exec, s[96:97]
s_cbranch_execz acc_retry_back_14
s_sub_u32 s98, s98, 1
s_cmp_lg_u32 s98, 0
s_cbranch_scc1 acc_retry_loop_14
s_mov_b64 s[76:77], exec
s_bitset1_b32 s23, 14
s_branch acc_retry_back_14
acc_retry_15:
s_mov_b64 s[96:97], vcc
s_andn2_b64 exec, exec, vcc
ds_write_b64 v15, v[70:71]
s_mov_b64 exec, s[96:97]
s_mov_b32 s98, 12
acc_retry_loop_15:
v_add_u32 v11, 4, v11
v_cmp_le_u32 vcc, 896, v11
v_subrev_u32 v16, 896, v11
s_nop 0
v_cndmask_b32 v11, v11, v16, vcc
ds_add_rtn_u32 v15, v11, v26 offset:25664
v_mad_u32_u24 v76, v11, v77, s37
s_waitcnt lgkmcnt(0)
v_cmp_ge_u32 vcc, v15, v76
s_mov_b64 s[96:97], vcc
s_andn2_b64 exec, exec, vcc
ds_write_b64 v15, v[70:71]
s_mov_b64 exec, s[96:97]
s_cbranch_execz acc_retry_back_15
s_sub_u32 s98, s98, 1
s_cmp_lg_u32 s98, 0
s_cbranch_scc1 acc_retry_loop_15
s_mov_b64 s[78:79], exec
s_bitset1_b32 s23, 15
s_branch acc_retry_back_15
acc_retry_16:
s_mov_b64 s[96:97], vcc
s_andn2_b64 exec, exec, vcc
ds_write_b64 v12, v[64:65]
s_mov_b64 exec, s[96:97]
s_mov_b32 s98, 12
acc_retry_loop_16:
v_add_u32 v8, 4, v8
v_cmp_le_u32 vcc, 896, v8
v_subrev_u32 v16, 896, v8
s_nop 0
v_cndmask_b32 v8, v8, v16, vcc
ds_add_rtn_u32 v12, v8, v26 offset:25664
v_mad_u32_u24 v73, v8, v77, s37
s_waitcnt lgkmcnt(0)
v_cmp_ge_u32 vcc, v12, v73
s_mov_b64 s[96:97], vcc
s_andn2_b64 exec, exec, vcc
ds_write_b64 v12, v[64:65]
s_mov_b64 exec, s[96:97]
s_cbranch_execz acc_retry_back_16
s_sub_u32 s98, s98, 1
s_cmp_lg_u32 s98, 0
s_cbranch_scc1 acc_retry_loop_16
s_mov_b64 s[8:9], exec
s_bitset1_b32 s23, 16
s_branch acc_retry_back_16
acc_retry_17:
s_mov_b64 s[96:97], vcc
s_andn2_b64 exec, exec, vcc
ds_write_b64 v13, v[66:67]
s_mov_b64 exec, s[96:97]
s_mov_b32 s98, 12
acc_retry_loop_17:
v_add_u32 v9, 4, v9
v_cmp_le_u32 vcc, 896, v9
v_subrev_u32 v16, 896, v9
s_nop 0
v_cndmask_b32 v9, v9, v16, vcc
ds_add_rtn_u32 v13, v9, v26 offset:25664
v_mad_u32_u24 v74, v9, v77, s37
s_waitcnt lgkmcnt(0)
v_cmp_ge_u32 vcc, v13, v74
s_mov_b64 s[96:97], vcc
s_andn2_b64 exec, exec, vcc
ds_write_b64 v13, v[66:67]
s_mov_b64 exec, s[96:97]
s_cbranch_execz acc_retry_back_17
s_sub_u32 s98, s98, 1
s_cmp_lg_u32 s98, 0
s_cbranch_scc1 acc_retry_loop_17
s_mov_b64 s[40:41], exec
s_bitset1_b32 s23, 17
s_branch acc_retry_back_17
acc_save:
v_writelane_b32 v31, s48, 0
v_writelane_b32 v31, s49, 1
v_writelane_b32 v31, s50, 2
v_writelane_b32 v31, s51, 3
v_writelane_b32 v31, s52, 4
v_writelane_b32 v31, s53, 5
v_writelane_b32 v31, s54, 6
v_writelane_b32 v31, s55, 7
v_writelane_b32 v31, s56, 8
v_writelane_b32 v31, s57, 9
v_writelane_b32 v31, s58, 10
v_writelane_b32 v31, s59, 11
v_writelane_b32 v31, s60, 12
v_writelane_b32 v31, s61, 13
v_writelane_b32 v31, s62, 14
v_writelane_b32 v31, s63, 15
v_writelane_b32 v31, s64, 16
v_writelane_b32 v31, s65, 17
v_writelane_b32 v31, s66, 18
v_writelane_b32 v31, s67, 19
v_writelane_b32 v31, s68, 20
v_writelane_b32 v31, s69, 21
v_writelane_b32 v31, s70, 22
v_writelane_b32 v31, s71, 23
v_writelane_b32 v31, s72, 24
v_writelane_b32 v31, s73, 25
v_writelane_b32 v31, s74, 26
v_writelane_b32 v31, s75, 27
v_writelane_b32 v31, s76, 28
v_writelane_b32 v31, s77, 29
v_writelane_b32 v31, s78, 30
v_writelane_b32 v31, s79, 31
v_writelane_b32 v31, s8, 32
v_writelane_b32 v31, s9, 33
v_writelane_b32 v31, s40, 34
v_writelane_b32 v31, s41, 35
s_branch acc_save_back
acc_redo:
s_barrier
v_lshlrev_b32 v10, 4, v1
v_lshlrev_b32 v12, 3, v1
ds_read_b128 v[80:83], v10 offset:26688
ds_read_b128 v[84:87], v10 offset:27712
ds_read_b64 v[88:89], v12 offset:28736
s_sub_u32 s37, s22, 4
s_cmp_lt_u32 s37, 10
s_cbranch_scc0 acc_redo_noz
v_mov_b32 v12, 0
v_mov_b32 v13, 0
v_mov_b32 v14, 0
v_mov_b32 v15, 0
v_subrev_u32 v8, 256, v0
v_lshlrev_b32 v8, 4, v8
ds_write_b128 v8, v[12:15] offset:29248
acc_redo_noz:
s_waitcnt lgkmcnt(0)
v_max3_u32 v80, v80, v81, v82
v_max3_u32 v84, v84, v85, v86
v_max3_u32 v80, v80, v83, v87
v_max3_u32 v80, v80, v88, v89
v_max_u32 v80, v80, v84
s_nop 1
v_max_u32_dpp v80, v80, v80 row_shr:1 row_mask:0xf bank_mask:0xf bound_ctrl:0
s_nop 1
v_max_u32_dpp v80, v80, v80 row_shr:2 row_mask:0xf bank_mask:0xf bound_ctrl:0
s_nop 1
v_max_u32_dpp v80, v80, v80 row_shr:4 row_mask:0xf bank_mask:0xf bound_ctrl:0
s_nop 1
v_max_u32_dpp v80, v80, v80 row_shr:8 row_mask:0xf bank_mask:0xf bound_ctrl:0
s_nop 1
v_max_u32_dpp v80, v80, v80 row_bcast:15 row_mask:0xa bank_mask:0xf
s_nop 1
v_max_u32_dpp v80, v80, v80 row_bcast:31 row_mask:0xc bank_mask:0xf
s_nop 0
v_readlane_b32 s36, v80, 63
s_mov_b32 s42, 1
s_nop 1
v_mov_b32 v14, s36
s_barrier
s_branch acc_pass
acc_wide:
s_waitcnt vmcnt(0) lgkmcnt(0)
global_load_dwordx4 v[112:115], v3, s[32:33]
global_load_dwordx4 v[116:119], v3, s[32:33] offset:16
s_waitcnt vmcnt(0)
v_add_u32_sdwa v35, v2, v112 dst_sel:DWORD dst_unused:UNUSED_PAD src0_sel:DWORD src1_sel:WORD_0
v_add_u32_sdwa v39, v2, v113 dst_sel:DWORD dst_unused:UNUSED_PAD src0_sel:DWORD src1_sel:WORD_0
v_add_u32_sdwa v43, v2, v114 dst_sel:DWORD dst_unused:UNUSED_PAD src0_sel:DWORD src1_sel:WORD_0
v_add_u32_sdwa v47, v2, v115 dst_sel:DWORD dst_unused:UNUSED_PAD src0_sel:DWORD src1_sel:WORD_0
v_add_u32_sdwa v51, v2, v116 dst_sel:DWORD dst_unused:UNUSED_PAD src0_sel:DWORD src1_sel:WORD_0
v_add_u32_sdwa v55, v2, v117 dst_sel:DWORD dst_unused:UNUSED_PAD src0_sel:DWORD src1_sel:WORD_0
v_add_u32_sdwa v59, v2, v118 dst_sel:DWORD dst_unused:UNUSED_PAD src0_sel:DWORD src1_sel:WORD_0
v_add_u32_sdwa v63, v2, v119 dst_sel:DWORD dst_unused:UNUSED_PAD src0_sel:DWORD src1_sel:WORD_0
v_readlane_b32 s48, v31, 0
v_readlane_b32 s49, v31, 1
v_readlane_b32 s50, v31, 2
v_readlane_b32 s51, v31, 3
v_readlane_b32 s52, v31, 4
v_readlane_b32 s53, v31, 5
v_readlane_b32 s54, v31, 6
v_readlane_b32 s55, v31, 7
v_readlane_b32 s56, v31, 8
v_readlane_b32 s57, v31, 9
v_readlane_b32 s58, v31, 10
v_readlane_b32 s59, v31, 11
v_readlane_b32 s60, v31, 12
v_readlane_b32 s61, v31, 13
v_readlane_b32 s62, v31, 14
v_readlane_b32 s63, v31, 15
v_readlane_b32 s64, v31, 16
v_readlane_b32 s65, v31, 17
v_readlane_b32 s66, v31, 18
v_readlane_b32 s67, v31, 19
v_readlane_b32 s68, v31, 20
v_readlane_b32 s69, v31, 21
v_readlane_b32 s70, v31, 22
v_readlane_b32 s71, v31, 23
v_readlane_b32 s72, v31, 24
v_readlane_b32 s73, v31, 25
v_readlane_b32 s74, v31, 26
v_readlane_b32 s75, v31, 27
v_readlane_b32 s76, v31, 28
v_readlane_b32 s77, v31, 29
v_readlane_b32 s78, v31, 30
v_readlane_b32 s79, v31, 31
v_readlane_b32 s8, v31, 32
v_readlane_b32 s9, v31, 33
v_readlane_b32 s40, v31, 34
v_readlane_b32 s41, v31, 35
s_nop 1
s_bitcmp1_b32 s23, 0
s_cselect_b64 s[48:49], s[48:49], 0
s_bitcmp1_b32 s23, 1
s_cselect_b64 s[50:51], s[50:51], 0
s_bitcmp1_b32 s23, 2
s_cselect_b64 s[52:53], s[52:53], 0
s_bitcmp1_b32 s23, 3
s_cselect_b64 s[54:55], s[54:55], 0
s_bitcmp1_b32 s23, 4
s_cselect_b64 s[56:57], s[56:57], 0
s_bitcmp1_b32 s23, 5
s_cselect_b64 s[58:59], s[58:59], 0
s_bitcmp1_b32 s23, 6
s_cselect_b64 s[60:61], s[60:61], 0
s_bitcmp1_b32 s23, 7
s_cselect_b64 s[62:63], s[62:63], 0
s_bitcmp1_b32 s23, 8
s_cselect_b64 s[64:65], s[64:65], 0
s_bitcmp1_b32 s23, 9
s_cselect_b64 s[66:67], s[66:67], 0
s_bitcmp1_b32 s23, 10
s_cselect_b64 s[68:69], s[68:69], 0
s_bitcmp1_b32 s23, 11
s_cselect_b64 s[70:71], s[70:71], 0
s_bitcmp1_b32 s23, 12
s_cselect_b64 s[72:73], s[72:73], 0
s_bitcmp1_b32 s23, 13
s_cselect_b64 s[74:75], s[74:75], 0
s_bitcmp1_b32 s23, 14
s_cselect_b64 s[76:77], s[76:77], 0
s_bitcmp1_b32 s23, 15
s_cselect_b64 s[78:79], s[78:79], 0
s_bitcmp1_b32 s23, 16
s_cselect_b64 s[8:9], s[8:9], 0
s_bitcmp1_b32 s23, 17
s_cselect_b64 s[40:41], s[40:41], 0
s_mov_b32 s36, 0
s_or_b64 exec, s[48:49], s[50:51]
buffer_load_dwordx3 v[32:34], v35, s[24:27], s36 offen
s_mov_b32 s36, 61568
s_or_b64 exec, s[52:53], s[54:55]
buffer_load_dwordx3 v[36:38], v39, s[24:27], s36 offen
s_mov_b32 s36, 123136
s_or_b64 exec, s[56:57], s[58:59]
buffer_load_dwordx3 v[40:42], v43, s[24:27], s36 offen
s_mov_b32 s36, 184704
s_or_b64 exec, s[60:61], s[62:63]
buffer_load_dwordx3 v[44:46], v47, s[24:27], s36 offen
s_mov_b32 s36, 246272
s_or_b64 exec, s[64:65], s[66:67]
buffer_load_dwordx3 v[48:50], v51, s[24:27], s36 offen
s_mov_b32 s36, 307840
s_or_b64 exec, s[68:69], s[70:71]
buffer_load_dwordx3 v[52:54], v55, s[24:27], s36 offen
s_mov_b32 s36, 369408
s_or_b64 exec, s[72:73], s[74:75]
buffer_load_dwordx3 v[56:58], v59, s[24:27], s36 offen
s_mov_b32 s36, 430976
s_or_b64 exec, s[76:77], s[78:79]
buffer_load_dwordx3 v[60:62], v63, s[24:27], s36 offen
s_waitcnt vmcnt(0)
s_mov_b64 exec, s[48:49]
s_cbranch_execz acc_sb_1
v_lshrrev_b32 v122, 21, v32
v_and_b32 v120, v72, v32
v_lshl_or_b32 v121, v34, 16, v122
buffer_load_dwordx2 v[124:125], v120, s[28:31], 0 offen
v_lshlrev_b32_sdwa v106, 4, v121 dst_sel:DWORD dst_unused:UNUSED_PAD src0_sel:DWORD src1_sel:WORD_0
v_lshlrev_b32_sdwa v104, 3, v121 dst_sel:DWORD dst_unused:UNUSED_PAD src0_sel:DWORD src1_sel:WORD_0
ds_read_b128 v[80:83], v106 offset:0
ds_read_b64 v[84:85], v104 offset:10240
v_lshlrev_b32_sdwa v86, 2, v121 dst_sel:DWORD dst_unused:UNUSED_PAD src0_sel:DWORD src1_sel:WORD_0
v_and_b32 v107, v21, v121
v_mul_f32 v108, v22, v107
v_mul_f32 v109, v23, v107
v_mul_f32 v110, v24, v107
v_fract_f32 v108, v108
v_fract_f32 v109, v109
v_fract_f32 v110, v110
v_cos_f32 v108, v108
v_cos_f32 v109, v109
v_cos_f32 v110, v110
s_waitcnt vmcnt(0)
v_lshlrev_b32 v112, 16, v124
v_and_b32 v113, v21, v124
v_mul_f32 v108, v26, v108
v_mul_f32 v109, v26, v109
v_mul_f32 v110, v26, v110
v_lshlrev_b32 v114, 16, v125
v_and_b32 v115, v21, v125
s_waitcnt lgkmcnt(0)
v_max_u32 v75, v75, v73
v_fma_mix_f32 v116, v108, v80, 0 op_sel:[0,0,0] op_sel_hi:[0,1,0]
v_fma_mix_f32 v117, v108, v80, 0 op_sel:[0,1,0] op_sel_hi:[0,1,0]
v_fma_mix_f32 v118, v108, v81, 0 op_sel:[0,0,0] op_sel_hi:[0,1,0]
v_fma_mix_f32 v119, v108, v81, 0 op_sel:[0,1,0] op_sel_hi:[0,1,0]
v_fma_mix_f32 v116, v109, v82, v116 op_sel:[0,0,0] op_sel_hi:[0,1,0]
v_fma_mix_f32 v117, v109, v82, v117 op_sel:[0,1,0] op_sel_hi:[0,1,0]
v_fma_mix_f32 v118, v109, v83, v118 op_sel:[0,0,0] op_sel_hi:[0,1,0]
v_fma_mix_f32 v119, v109, v83, v119 op_sel:[0,1,0] op_sel_hi:[0,1,0]
v_fma_mix_f32 v116, v110, v84, v116 op_sel:[0,0,0] op_sel_hi:[0,1,0]
v_fma_mix_f32 v117, v110, v84, v117 op_sel:[0,1,0] op_sel_hi:[0,1,0]
v_fma_mix_f32 v118, v110, v85, v118 op_sel:[0,0,0] op_sel_hi:[0,1,0]
v_fma_mix_f32 v119, v110, v85, v119 op_sel:[0,1,0] op_sel_hi:[0,1,0]
v_pk_mul_f32 v[116:117], v[116:117], v[112:113]
v_pk_mul_f32 v[118:119], v[118:119], v[114:115]
v_cvt_rpi_i32_f32 v116, v116
v_cvt_rpi_i32_f32 v117, v117
v_cvt_rpi_i32_f32 v118, v118
v_cvt_rpi_i32_f32 v119, v119
ds_add_u32 v86, v116 offset:29248
ds_add_u32 v86, v117 offset:31808
ds_add_u32 v86, v118 offset:34368
ds_add_u32 v86, v119 offset:36928
ds_add_rtn_u32 v73, v86, v76 offset:26688
acc_sb_1:
s_mov_b64 exec, s[50:51]
s_cbranch_execz acc_sb_2
v_lshrrev_b32 v122, 21, v33
v_and_b32 v120, v72, v33
v_and_or_b32 v121, v34, v21, v122
buffer_load_dwordx2 v[124:125], v120, s[28:31], 0 offen
v_lshlrev_b32_sdwa v106, 4, v121 dst_sel:DWORD dst_unused:UNUSED_PAD src0_sel:DWORD src1_sel:WORD_0
v_lshlrev_b32_sdwa v104, 3, v121 dst_sel:DWORD dst_unused:UNUSED_PAD src0_sel:DWORD src1_sel:WORD_0
ds_read_b128 v[80:83], v106 offset:0
ds_read_b64 v[84:85], v104 offset:10240
v_lshlrev_b32_sdwa v86, 2, v121 dst_sel:DWORD dst_unused:UNUSED_PAD src0_sel:DWORD src1_sel:WORD_0
v_and_b32 v107, v21, v121
v_mul_f32 v108, v22, v107
v_mul_f32 v109, v23, v107
v_mul_f32 v110, v24, v107
v_fract_f32 v108, v108
v_fract_f32 v109, v109
v_fract_f32 v110, v110
v_cos_f32 v108, v108
v_cos_f32 v109, v109
v_cos_f32 v110, v110
s_waitcnt vmcnt(0)
v_lshlrev_b32 v112, 16, v124
v_and_b32 v113, v21, v124
v_mul_f32 v108, v26, v108
v_mul_f32 v109, v26, v109
v_mul_f32 v110, v26, v110
v_lshlrev_b32 v114, 16, v125
v_and_b32 v115, v21, v125
s_waitcnt lgkmcnt(0)
v_max_u32 v75, v75, v73
v_fma_mix_f32 v116, v108, v80, 0 op_sel:[0,0,0] op_sel_hi:[0,1,0]
v_fma_mix_f32 v117, v108, v80, 0 op_sel:[0,1,0] op_sel_hi:[0,1,0]
v_fma_mix_f32 v118, v108, v81, 0 op_sel:[0,0,0] op_sel_hi:[0,1,0]
v_fma_mix_f32 v119, v108, v81, 0 op_sel:[0,1,0] op_sel_hi:[0,1,0]
v_fma_mix_f32 v116, v109, v82, v116 op_sel:[0,0,0] op_sel_hi:[0,1,0]
v_fma_mix_f32 v117, v109, v82, v117 op_sel:[0,1,0] op_sel_hi:[0,1,0]
v_fma_mix_f32 v118, v109, v83, v118 op_sel:[0,0,0] op_sel_hi:[0,1,0]
v_fma_mix_f32 v119, v109, v83, v119 op_sel:[0,1,0] op_sel_hi:[0,1,0]
v_fma_mix_f32 v116, v110, v84, v116 op_sel:[0,0,0] op_sel_hi:[0,1,0]
v_fma_mix_f32 v117, v110, v84, v117 op_sel:[0,1,0] op_sel_hi:[0,1,0]
v_fma_mix_f32 v118, v110, v85, v118 op_sel:[0,0,0] op_sel_hi:[0,1,0]
v_fma_mix_f32 v119, v110, v85, v119 op_sel:[0,1,0] op_sel_hi:[0,1,0]
v_pk_mul_f32 v[116:117], v[116:117], v[112:113]
v_pk_mul_f32 v[118:119], v[118:119], v[114:115]
v_cvt_rpi_i32_f32 v116, v116
v_cvt_rpi_i32_f32 v117, v117
v_cvt_rpi_i32_f32 v118, v118
v_cvt_rpi_i32_f32 v119, v119
ds_add_u32 v86, v116 offset:29248
ds_add_u32 v86, v117 offset:31808
ds_add_u32 v86, v118 offset:34368
ds_add_u32 v86, v119 offset:36928
ds_add_rtn_u32 v73, v86, v76 offset:26688
acc_sb_2:
s_mov_b64 exec, s[52:53]
s_cbranch_execz acc_sb_3
v_lshrrev_b32 v122, 21, v36
v_and_b32 v120, v72, v36
v_lshl_or_b32 v121, v38, 16, v122
buffer_load_dwordx2 v[124:125], v120, s[28:31], 0 offen
v_lshlrev_b32_sdwa v106, 4, v121 dst_sel:DWORD dst_unused:UNUSED_PAD src0_sel:DWORD src1_sel:WORD_0
v_lshlrev_b32_sdwa v104, 3, v121 dst_sel:DWORD dst_unused:UNUSED_PAD src0_sel:DWORD src1_sel:WORD_0
ds_read_b128 v[80:83], v106 offset:0
ds_read_b64 v[84:85], v104 offset:10240
v_lshlrev_b32_sdwa v86, 2, v121 dst_sel:DWORD dst_unused:UNUSED_PAD src0_sel:DWORD src1_sel:WORD_0
v_and_b32 v107, v21, v121
v_mul_f32 v108, v22, v107
v_mul_f32 v109, v23, v107
v_mul_f32 v110, v24, v107
v_fract_f32 v108, v108
v_fract_f32 v109, v109
v_fract_f32 v110, v110
v_cos_f32 v108, v108
v_cos_f32 v109, v109
v_cos_f32 v110, v110
s_waitcnt vmcnt(0)
v_lshlrev_b32 v112, 16, v124
v_and_b32 v113, v21, v124
v_mul_f32 v108, v26, v108
v_mul_f32 v109, v26, v109
v_mul_f32 v110, v26, v110
v_lshlrev_b32 v114, 16, v125
v_and_b32 v115, v21, v125
s_waitcnt lgkmcnt(0)
v_max_u32 v75, v75, v73
v_fma_mix_f32 v116, v108, v80, 0 op_sel:[0,0,0] op_sel_hi:[0,1,0]
v_fma_mix_f32 v117, v108, v80, 0 op_sel:[0,1,0] op_sel_hi:[0,1,0]
v_fma_mix_f32 v118, v108, v81, 0 op_sel:[0,0,0] op_sel_hi:[0,1,0]
v_fma_mix_f32 v119, v108, v81, 0 op_sel:[0,1,0] op_sel_hi:[0,1,0]
v_fma_mix_f32 v116, v109, v82, v116 op_sel:[0,0,0] op_sel_hi:[0,1,0]
v_fma_mix_f32 v117, v109, v82, v117 op_sel:[0,1,0] op_sel_hi:[0,1,0]
v_fma_mix_f32 v118, v109, v83, v118 op_sel:[0,0,0] op_sel_hi:[0,1,0]
v_fma_mix_f32 v119, v109, v83, v119 op_sel:[0,1,0] op_sel_hi:[0,1,0]
v_fma_mix_f32 v116, v110, v84, v116 op_sel:[0,0,0] op_sel_hi:[0,1,0]
v_fma_mix_f32 v117, v110, v84, v117 op_sel:[0,1,0] op_sel_hi:[0,1,0]
v_fma_mix_f32 v118, v110, v85, v118 op_sel:[0,0,0] op_sel_hi:[0,1,0]
v_fma_mix_f32 v119, v110, v85, v119 op_sel:[0,1,0] op_sel_hi:[0,1,0]
v_pk_mul_f32 v[116:117], v[116:117], v[112:113]
v_pk_mul_f32 v[118:119], v[118:119], v[114:115]
v_cvt_rpi_i32_f32 v116, v116
v_cvt_rpi_i32_f32 v117, v117
v_cvt_rpi_i32_f32 v118, v118
v_cvt_rpi_i32_f32 v119, v119
ds_add_u32 v86, v116 offset:29248
ds_add_u32 v86, v117 offset:31808
ds_add_u32 v86, v118 offset:34368
ds_add_u32 v86, v119 offset:36928
ds_add_rtn_u32 v73, v86, v76 offset:26688
acc_sb_3:
s_mov_b64 exec, s[54:55]
s_cbranch_execz acc_sb_4
v_lshrrev_b32 v122, 21, v37
v_and_b32 v120, v72, v37
v_and_or_b32 v121, v38, v21, v122
buffer_load_dwordx2 v[124:125], v120, s[28:31], 0 offen
v_lshlrev_b32_sdwa v106, 4, v121 dst_sel:DWORD dst_unused:UNUSED_PAD src0_sel:DWORD src1_sel:WORD_0
v_lshlrev_b32_sdwa v104, 3, v121 dst_sel:DWORD dst_unused:UNUSED_PAD src0_sel:DWORD src1_sel:WORD_0
ds_read_b128 v[80:83], v106 offset:0
ds_read_b64 v[84:85], v104 offset:10240
v_lshlrev_b32_sdwa v86, 2, v121 dst_sel:DWORD dst_unused:UNUSED_PAD src0_sel:DWORD src1_sel:WORD_0
v_and_b32 v107, v21, v121
v_mul_f32 v108, v22, v107
v_mul_f32 v109, v23, v107
v_mul_f32 v110, v24, v107
v_fract_f32 v108, v108
v_fract_f32 v109, v109
v_fract_f32 v110, v110
v_cos_f32 v108, v108
v_cos_f32 v109, v109
v_cos_f32 v110, v110
s_waitcnt vmcnt(0)
v_lshlrev_b32 v112, 16, v124
v_and_b32 v113, v21, v124
v_mul_f32 v108, v26, v108
v_mul_f32 v109, v26, v109
v_mul_f32 v110, v26, v110
v_lshlrev_b32 v114, 16, v125
v_and_b32 v115, v21, v125
s_waitcnt lgkmcnt(0)
v_max_u32 v75, v75, v73
v_fma_mix_f32 v116, v108, v80, 0 op_sel:[0,0,0] op_sel_hi:[0,1,0]
v_fma_mix_f32 v117, v108, v80, 0 op_sel:[0,1,0] op_sel_hi:[0,1,0]
v_fma_mix_f32 v118, v108, v81, 0 op_sel:[0,0,0] op_sel_hi:[0,1,0]
v_fma_mix_f32 v119, v108, v81, 0 op_sel:[0,1,0] op_sel_hi:[0,1,0]
v_fma_mix_f32 v116, v109, v82, v116 op_sel:[0,0,0] op_sel_hi:[0,1,0]
v_fma_mix_f32 v117, v109, v82, v117 op_sel:[0,1,0] op_sel_hi:[0,1,0]
v_fma_mix_f32 v118, v109, v83, v118 op_sel:[0,0,0] op_sel_hi:[0,1,0]
v_fma_mix_f32 v119, v109, v83, v119 op_sel:[0,1,0] op_sel_hi:[0,1,0]
v_fma_mix_f32 v116, v110, v84, v116 op_sel:[0,0,0] op_sel_hi:[0,1,0]
v_fma_mix_f32 v117, v110, v84, v117 op_sel:[0,1,0] op_sel_hi:[0,1,0]
v_fma_mix_f32 v118, v110, v85, v118 op_sel:[0,0,0] op_sel_hi:[0,1,0]
v_fma_mix_f32 v119, v110, v85, v119 op_sel:[0,1,0] op_sel_hi:[0,1,0]
v_pk_mul_f32 v[116:117], v[116:117], v[112:113]
v_pk_mul_f32 v[118:119], v[118:119], v[114:115]
v_cvt_rpi_i32_f32 v116, v116
v_cvt_rpi_i32_f32 v117, v117
v_cvt_rpi_i32_f32 v118, v118
v_cvt_rpi_i32_f32 v119, v119
ds_add_u32 v86, v116 offset:29248
ds_add_u32 v86, v117 offset:31808
ds_add_u32 v86, v118 offset:34368
ds_add_u32 v86, v119 offset:36928
ds_add_rtn_u32 v73, v86, v76 offset:26688
acc_sb_4:
s_mov_b64 exec, s[56:57]
s_cbranch_execz acc_sb_5
v_lshrrev_b32 v122, 21, v40
v_and_b32 v120, v72, v40
v_lshl_or_b32 v121, v42, 16, v122
buffer_load_dwordx2 v[124:125], v120, s[28:31], 0 offen
v_lshlrev_b32_sdwa v106, 4, v121 dst_sel:DWORD dst_unused:UNUSED_PAD src0_sel:DWORD src1_sel:WORD_0
v_lshlrev_b32_sdwa v104, 3, v121 dst_sel:DWORD dst_unused:UNUSED_PAD src0_sel:DWORD src1_sel:WORD_0
ds_read_b128 v[80:83], v106 offset:0
ds_read_b64 v[84:85], v104 offset:10240
v_lshlrev_b32_sdwa v86, 2, v121 dst_sel:DWORD dst_unused:UNUSED_PAD src0_sel:DWORD src1_sel:WORD_0
v_and_b32 v107, v21, v121
v_mul_f32 v108, v22, v107
v_mul_f32 v109, v23, v107
v_mul_f32 v110, v24, v107
v_fract_f32 v108, v108
v_fract_f32 v109, v109
v_fract_f32 v110, v110
v_cos_f32 v108, v108
v_cos_f32 v109, v109
v_cos_f32 v110, v110
s_waitcnt vmcnt(0)
v_lshlrev_b32 v112, 16, v124
v_and_b32 v113, v21, v124
v_mul_f32 v108, v26, v108
v_mul_f32 v109, v26, v109
v_mul_f32 v110, v26, v110
v_lshlrev_b32 v114, 16, v125
v_and_b32 v115, v21, v125
s_waitcnt lgkmcnt(0)
v_max_u32 v75, v75, v73
v_fma_mix_f32 v116, v108, v80, 0 op_sel:[0,0,0] op_sel_hi:[0,1,0]
v_fma_mix_f32 v117, v108, v80, 0 op_sel:[0,1,0] op_sel_hi:[0,1,0]
v_fma_mix_f32 v118, v108, v81, 0 op_sel:[0,0,0] op_sel_hi:[0,1,0]
v_fma_mix_f32 v119, v108, v81, 0 op_sel:[0,1,0] op_sel_hi:[0,1,0]
v_fma_mix_f32 v116, v109, v82, v116 op_sel:[0,0,0] op_sel_hi:[0,1,0]
v_fma_mix_f32 v117, v109, v82, v117 op_sel:[0,1,0] op_sel_hi:[0,1,0]
v_fma_mix_f32 v118, v109, v83, v118 op_sel:[0,0,0] op_sel_hi:[0,1,0]
v_fma_mix_f32 v119, v109, v83, v119 op_sel:[0,1,0] op_sel_hi:[0,1,0]
v_fma_mix_f32 v116, v110, v84, v116 op_sel:[0,0,0] op_sel_hi:[0,1,0]
v_fma_mix_f32 v117, v110, v84, v117 op_sel:[0,1,0] op_sel_hi:[0,1,0]
v_fma_mix_f32 v118, v110, v85, v118 op_sel:[0,0,0] op_sel_hi:[0,1,0]
v_fma_mix_f32 v119, v110, v85, v119 op_sel:[0,1,0] op_sel_hi:[0,1,0]
v_pk_mul_f32 v[116:117], v[116:117], v[112:113]
v_pk_mul_f32 v[118:119], v[118:119], v[114:115]
v_cvt_rpi_i32_f32 v116, v116
v_cvt_rpi_i32_f32 v117, v117
v_cvt_rpi_i32_f32 v118, v118
v_cvt_rpi_i32_f32 v119, v119
ds_add_u32 v86, v116 offset:29248
ds_add_u32 v86, v117 offset:31808
ds_add_u32 v86, v118 offset:34368
ds_add_u32 v86, v119 offset:36928
ds_add_rtn_u32 v73, v86, v76 offset:26688
acc_sb_5:
s_mov_b64 exec, s[58:59]
s_cbranch_execz acc_sb_6
v_lshrrev_b32 v122, 21, v41
v_and_b32 v120, v72, v41
v_and_or_b32 v121, v42, v21, v122
buffer_load_dwordx2 v[124:125], v120, s[28:31], 0 offen
v_lshlrev_b32_sdwa v106, 4, v121 dst_sel:DWORD dst_unused:UNUSED_PAD src0_sel:DWORD src1_sel:WORD_0
v_lshlrev_b32_sdwa v104, 3, v121 dst_sel:DWORD dst_unused:UNUSED_PAD src0_sel:DWORD src1_sel:WORD_0
ds_read_b128 v[80:83], v106 offset:0
ds_read_b64 v[84:85], v104 offset:10240
v_lshlrev_b32_sdwa v86, 2, v121 dst_sel:DWORD dst_unused:UNUSED_PAD src0_sel:DWORD src1_sel:WORD_0
v_and_b32 v107, v21, v121
v_mul_f32 v108, v22, v107
v_mul_f32 v109, v23, v107
v_mul_f32 v110, v24, v107
v_fract_f32 v108, v108
v_fract_f32 v109, v109
v_fract_f32 v110, v110
v_cos_f32 v108, v108
v_cos_f32 v109, v109
v_cos_f32 v110, v110
s_waitcnt vmcnt(0)
v_lshlrev_b32 v112, 16, v124
v_and_b32 v113, v21, v124
v_mul_f32 v108, v26, v108
v_mul_f32 v109, v26, v109
v_mul_f32 v110, v26, v110
v_lshlrev_b32 v114, 16, v125
v_and_b32 v115, v21, v125
s_waitcnt lgkmcnt(0)
v_max_u32 v75, v75, v73
v_fma_mix_f32 v116, v108, v80, 0 op_sel:[0,0,0] op_sel_hi:[0,1,0]
v_fma_mix_f32 v117, v108, v80, 0 op_sel:[0,1,0] op_sel_hi:[0,1,0]
v_fma_mix_f32 v118, v108, v81, 0 op_sel:[0,0,0] op_sel_hi:[0,1,0]
v_fma_mix_f32 v119, v108, v81, 0 op_sel:[0,1,0] op_sel_hi:[0,1,0]
v_fma_mix_f32 v116, v109, v82, v116 op_sel:[0,0,0] op_sel_hi:[0,1,0]
v_fma_mix_f32 v117, v109, v82, v117 op_sel:[0,1,0] op_sel_hi:[0,1,0]
v_fma_mix_f32 v118, v109, v83, v118 op_sel:[0,0,0] op_sel_hi:[0,1,0]
v_fma_mix_f32 v119, v109, v83, v119 op_sel:[0,1,0] op_sel_hi:[0,1,0]
v_fma_mix_f32 v116, v110, v84, v116 op_sel:[0,0,0] op_sel_hi:[0,1,0]
v_fma_mix_f32 v117, v110, v84, v117 op_sel:[0,1,0] op_sel_hi:[0,1,0]
v_fma_mix_f32 v118, v110, v85, v118 op_sel:[0,0,0] op_sel_hi:[0,1,0]
v_fma_mix_f32 v119, v110, v85, v119 op_sel:[0,1,0] op_sel_hi:[0,1,0]
v_pk_mul_f32 v[116:117], v[116:117], v[112:113]
v_pk_mul_f32 v[118:119], v[118:119], v[114:115]
v_cvt_rpi_i32_f32 v116, v116
v_cvt_rpi_i32_f32 v117, v117
v_cvt_rpi_i32_f32 v118, v118
v_cvt_rpi_i32_f32 v119, v119
ds_add_u32 v86, v116 offset:29248
ds_add_u32 v86, v117 offset:31808
ds_add_u32 v86, v118 offset:34368
ds_add_u32 v86, v119 offset:36928
ds_add_rtn_u32 v73, v86, v76 offset:26688
acc_sb_6:
s_mov_b64 exec, s[60:61]
s_cbranch_execz acc_sb_7
v_lshrrev_b32 v122, 21, v44
v_and_b32 v120, v72, v44
v_lshl_or_b32 v121, v46, 16, v122
buffer_load_dwordx2 v[124:125], v120, s[28:31], 0 offen
v_lshlrev_b32_sdwa v106, 4, v121 dst_sel:DWORD dst_unused:UNUSED_PAD src0_sel:DWORD src1_sel:WORD_0
v_lshlrev_b32_sdwa v104, 3, v121 dst_sel:DWORD dst_unused:UNUSED_PAD src0_sel:DWORD src1_sel:WORD_0
ds_read_b128 v[80:83], v106 offset:0
ds_read_b64 v[84:85], v104 offset:10240
v_lshlrev_b32_sdwa v86, 2, v121 dst_sel:DWORD dst_unused:UNUSED_PAD src0_sel:DWORD src1_sel:WORD_0
v_and_b32 v107, v21, v121
v_mul_f32 v108, v22, v107
v_mul_f32 v109, v23, v107
v_mul_f32 v110, v24, v107
v_fract_f32 v108, v108
v_fract_f32 v109, v109
v_fract_f32 v110, v110
v_cos_f32 v108, v108
v_cos_f32 v109, v109
v_cos_f32 v110, v110
s_waitcnt vmcnt(0)
v_lshlrev_b32 v112, 16, v124
v_and_b32 v113, v21, v124
v_mul_f32 v108, v26, v108
v_mul_f32 v109, v26, v109
v_mul_f32 v110, v26, v110
v_lshlrev_b32 v114, 16, v125
v_and_b32 v115, v21, v125
s_waitcnt lgkmcnt(0)
v_max_u32 v75, v75, v73
v_fma_mix_f32 v116, v108, v80, 0 op_sel:[0,0,0] op_sel_hi:[0,1,0]
v_fma_mix_f32 v117, v108, v80, 0 op_sel:[0,1,0] op_sel_hi:[0,1,0]
v_fma_mix_f32 v118, v108, v81, 0 op_sel:[0,0,0] op_sel_hi:[0,1,0]
v_fma_mix_f32 v119, v108, v81, 0 op_sel:[0,1,0] op_sel_hi:[0,1,0]
v_fma_mix_f32 v116, v109, v82, v116 op_sel:[0,0,0] op_sel_hi:[0,1,0]
v_fma_mix_f32 v117, v109, v82, v117 op_sel:[0,1,0] op_sel_hi:[0,1,0]
v_fma_mix_f32 v118, v109, v83, v118 op_sel:[0,0,0] op_sel_hi:[0,1,0]
v_fma_mix_f32 v119, v109, v83, v119 op_sel:[0,1,0] op_sel_hi:[0,1,0]
v_fma_mix_f32 v116, v110, v84, v116 op_sel:[0,0,0] op_sel_hi:[0,1,0]
v_fma_mix_f32 v117, v110, v84, v117 op_sel:[0,1,0] op_sel_hi:[0,1,0]
v_fma_mix_f32 v118, v110, v85, v118 op_sel:[0,0,0] op_sel_hi:[0,1,0]
v_fma_mix_f32 v119, v110, v85, v119 op_sel:[0,1,0] op_sel_hi:[0,1,0]
v_pk_mul_f32 v[116:117], v[116:117], v[112:113]
v_pk_mul_f32 v[118:119], v[118:119], v[114:115]
v_cvt_rpi_i32_f32 v116, v116
v_cvt_rpi_i32_f32 v117, v117
v_cvt_rpi_i32_f32 v118, v118
v_cvt_rpi_i32_f32 v119, v119
ds_add_u32 v86, v116 offset:29248
ds_add_u32 v86, v117 offset:31808
ds_add_u32 v86, v118 offset:34368
ds_add_u32 v86, v119 offset:36928
ds_add_rtn_u32 v73, v86, v76 offset:26688
acc_sb_7:
s_mov_b64 exec, s[62:63]
s_cbranch_execz acc_sb_8
v_lshrrev_b32 v122, 21, v45
v_and_b32 v120, v72, v45
v_and_or_b32 v121, v46, v21, v122
buffer_load_dwordx2 v[124:125], v120, s[28:31], 0 offen
v_lshlrev_b32_sdwa v106, 4, v121 dst_sel:DWORD dst_unused:UNUSED_PAD src0_sel:DWORD src1_sel:WORD_0
v_lshlrev_b32_sdwa v104, 3, v121 dst_sel:DWORD dst_unused:UNUSED_PAD src0_sel:DWORD src1_sel:WORD_0
ds_read_b128 v[80:83], v106 offset:0
ds_read_b64 v[84:85], v104 offset:10240
v_lshlrev_b32_sdwa v86, 2, v121 dst_sel:DWORD dst_unused:UNUSED_PAD src0_sel:DWORD src1_sel:WORD_0
v_and_b32 v107, v21, v121
v_mul_f32 v108, v22, v107
v_mul_f32 v109, v23, v107
v_mul_f32 v110, v24, v107
v_fract_f32 v108, v108
v_fract_f32 v109, v109
v_fract_f32 v110, v110
v_cos_f32 v108, v108
v_cos_f32 v109, v109
v_cos_f32 v110, v110
s_waitcnt vmcnt(0)
v_lshlrev_b32 v112, 16, v124
v_and_b32 v113, v21, v124
v_mul_f32 v108, v26, v108
v_mul_f32 v109, v26, v109
v_mul_f32 v110, v26, v110
v_lshlrev_b32 v114, 16, v125
v_and_b32 v115, v21, v125
s_waitcnt lgkmcnt(0)
v_max_u32 v75, v75, v73
v_fma_mix_f32 v116, v108, v80, 0 op_sel:[0,0,0] op_sel_hi:[0,1,0]
v_fma_mix_f32 v117, v108, v80, 0 op_sel:[0,1,0] op_sel_hi:[0,1,0]
v_fma_mix_f32 v118, v108, v81, 0 op_sel:[0,0,0] op_sel_hi:[0,1,0]
v_fma_mix_f32 v119, v108, v81, 0 op_sel:[0,1,0] op_sel_hi:[0,1,0]
v_fma_mix_f32 v116, v109, v82, v116 op_sel:[0,0,0] op_sel_hi:[0,1,0]
v_fma_mix_f32 v117, v109, v82, v117 op_sel:[0,1,0] op_sel_hi:[0,1,0]
v_fma_mix_f32 v118, v109, v83, v118 op_sel:[0,0,0] op_sel_hi:[0,1,0]
v_fma_mix_f32 v119, v109, v83, v119 op_sel:[0,1,0] op_sel_hi:[0,1,0]
v_fma_mix_f32 v116, v110, v84, v116 op_sel:[0,0,0] op_sel_hi:[0,1,0]
v_fma_mix_f32 v117, v110, v84, v117 op_sel:[0,1,0] op_sel_hi:[0,1,0]
v_fma_mix_f32 v118, v110, v85, v118 op_sel:[0,0,0] op_sel_hi:[0,1,0]
v_fma_mix_f32 v119, v110, v85, v119 op_sel:[0,1,0] op_sel_hi:[0,1,0]
v_pk_mul_f32 v[116:117], v[116:117], v[112:113]
v_pk_mul_f32 v[118:119], v[118:119], v[114:115]
v_cvt_rpi_i32_f32 v116, v116
v_cvt_rpi_i32_f32 v117, v117
v_cvt_rpi_i32_f32 v118, v118
v_cvt_rpi_i32_f32 v119, v119
ds_add_u32 v86, v116 offset:29248
ds_add_u32 v86, v117 offset:31808
ds_add_u32 v86, v118 offset:34368
ds_add_u32 v86, v119 offset:36928
ds_add_rtn_u32 v73, v86, v76 offset:26688
acc_sb_8:
s_mov_b64 exec, s[64:65]
s_cbranch_execz acc_sb_9
v_lshrrev_b32 v122, 21, v48
v_and_b32 v120, v72, v48
v_lshl_or_b32 v121, v50, 16, v122
buffer_load_dwordx2 v[124:125], v120, s[28:31], 0 offen
v_lshlrev_b32_sdwa v106, 4, v121 dst_sel:DWORD dst_unused:UNUSED_PAD src0_sel:DWORD src1_sel:WORD_0
v_lshlrev_b32_sdwa v104, 3, v121 dst_sel:DWORD dst_unused:UNUSED_PAD src0_sel:DWORD src1_sel:WORD_0
ds_read_b128 v[80:83], v106 offset:0
ds_read_b64 v[84:85], v104 offset:10240
v_lshlrev_b32_sdwa v86, 2, v121 dst_sel:DWORD dst_unused:UNUSED_PAD src0_sel:DWORD src1_sel:WORD_0
v_and_b32 v107, v21, v121
v_mul_f32 v108, v22, v107
v_mul_f32 v109, v23, v107
v_mul_f32 v110, v24, v107
v_fract_f32 v108, v108
v_fract_f32 v109, v109
v_fract_f32 v110, v110
v_cos_f32 v108, v108
v_cos_f32 v109, v109
v_cos_f32 v110, v110
s_waitcnt vmcnt(0)
v_lshlrev_b32 v112, 16, v124
v_and_b32 v113, v21, v124
v_mul_f32 v108, v26, v108
v_mul_f32 v109, v26, v109
v_mul_f32 v110, v26, v110
v_lshlrev_b32 v114, 16, v125
v_and_b32 v115, v21, v125
s_waitcnt lgkmcnt(0)
v_max_u32 v75, v75, v73
v_fma_mix_f32 v116, v108, v80, 0 op_sel:[0,0,0] op_sel_hi:[0,1,0]
v_fma_mix_f32 v117, v108, v80, 0 op_sel:[0,1,0] op_sel_hi:[0,1,0]
v_fma_mix_f32 v118, v108, v81, 0 op_sel:[0,0,0] op_sel_hi:[0,1,0]
v_fma_mix_f32 v119, v108, v81, 0 op_sel:[0,1,0] op_sel_hi:[0,1,0]
v_fma_mix_f32 v116, v109, v82, v116 op_sel:[0,0,0] op_sel_hi:[0,1,0]
v_fma_mix_f32 v117, v109, v82, v117 op_sel:[0,1,0] op_sel_hi:[0,1,0]
v_fma_mix_f32 v118, v109, v83, v118 op_sel:[0,0,0] op_sel_hi:[0,1,0]
v_fma_mix_f32 v119, v109, v83, v119 op_sel:[0,1,0] op_sel_hi:[0,1,0]
v_fma_mix_f32 v116, v110, v84, v116 op_sel:[0,0,0] op_sel_hi:[0,1,0]
v_fma_mix_f32 v117, v110, v84, v117 op_sel:[0,1,0] op_sel_hi:[0,1,0]
v_fma_mix_f32 v118, v110, v85, v118 op_sel:[0,0,0] op_sel_hi:[0,1,0]
v_fma_mix_f32 v119, v110, v85, v119 op_sel:[0,1,0] op_sel_hi:[0,1,0]
v_pk_mul_f32 v[116:117], v[116:117], v[112:113]
v_pk_mul_f32 v[118:119], v[118:119], v[114:115]
v_cvt_rpi_i32_f32 v116, v116
v_cvt_rpi_i32_f32 v117, v117
v_cvt_rpi_i32_f32 v118, v118
v_cvt_rpi_i32_f32 v119, v119
ds_add_u32 v86, v116 offset:29248
ds_add_u32 v86, v117 offset:31808
ds_add_u32 v86, v118 offset:34368
ds_add_u32 v86, v119 offset:36928
ds_add_rtn_u32 v73, v86, v76 offset:26688
acc_sb_9:
s_mov_b64 exec, s[66:67]
s_cbranch_execz acc_sb_10
v_lshrrev_b32 v122, 21, v49
v_and_b32 v120, v72, v49
v_and_or_b32 v121, v50, v21, v122
buffer_load_dwordx2 v[124:125], v120, s[28:31], 0 offen
v_lshlrev_b32_sdwa v106, 4, v121 dst_sel:DWORD dst_unused:UNUSED_PAD src0_sel:DWORD src1_sel:WORD_0
v_lshlrev_b32_sdwa v104, 3, v121 dst_sel:DWORD dst_unused:UNUSED_PAD src0_sel:DWORD src1_sel:WORD_0
ds_read_b128 v[80:83], v106 offset:0
ds_read_b64 v[84:85], v104 offset:10240
v_lshlrev_b32_sdwa v86, 2, v121 dst_sel:DWORD dst_unused:UNUSED_PAD src0_sel:DWORD src1_sel:WORD_0
v_and_b32 v107, v21, v121
v_mul_f32 v108, v22, v107
v_mul_f32 v109, v23, v107
v_mul_f32 v110, v24, v107
v_fract_f32 v108, v108
v_fract_f32 v109, v109
v_fract_f32 v110, v110
v_cos_f32 v108, v108
v_cos_f32 v109, v109
v_cos_f32 v110, v110
s_waitcnt vmcnt(0)
v_lshlrev_b32 v112, 16, v124
v_and_b32 v113, v21, v124
v_mul_f32 v108, v26, v108
v_mul_f32 v109, v26, v109
v_mul_f32 v110, v26, v110
v_lshlrev_b32 v114, 16, v125
v_and_b32 v115, v21, v125
s_waitcnt lgkmcnt(0)
v_max_u32 v75, v75, v73
v_fma_mix_f32 v116, v108, v80, 0 op_sel:[0,0,0] op_sel_hi:[0,1,0]
v_fma_mix_f32 v117, v108, v80, 0 op_sel:[0,1,0] op_sel_hi:[0,1,0]
v_fma_mix_f32 v118, v108, v81, 0 op_sel:[0,0,0] op_sel_hi:[0,1,0]
v_fma_mix_f32 v119, v108, v81, 0 op_sel:[0,1,0] op_sel_hi:[0,1,0]
v_fma_mix_f32 v116, v109, v82, v116 op_sel:[0,0,0] op_sel_hi:[0,1,0]
v_fma_mix_f32 v117, v109, v82, v117 op_sel:[0,1,0] op_sel_hi:[0,1,0]
v_fma_mix_f32 v118, v109, v83, v118 op_sel:[0,0,0] op_sel_hi:[0,1,0]
v_fma_mix_f32 v119, v109, v83, v119 op_sel:[0,1,0] op_sel_hi:[0,1,0]
v_fma_mix_f32 v116, v110, v84, v116 op_sel:[0,0,0] op_sel_hi:[0,1,0]
v_fma_mix_f32 v117, v110, v84, v117 op_sel:[0,1,0] op_sel_hi:[0,1,0]
v_fma_mix_f32 v118, v110, v85, v118 op_sel:[0,0,0] op_sel_hi:[0,1,0]
v_fma_mix_f32 v119, v110, v85, v119 op_sel:[0,1,0] op_sel_hi:[0,1,0]
v_pk_mul_f32 v[116:117], v[116:117], v[112:113]
v_pk_mul_f32 v[118:119], v[118:119], v[114:115]
v_cvt_rpi_i32_f32 v116, v116
v_cvt_rpi_i32_f32 v117, v117
v_cvt_rpi_i32_f32 v118, v118
v_cvt_rpi_i32_f32 v119, v119
ds_add_u32 v86, v116 offset:29248
ds_add_u32 v86, v117 offset:31808
ds_add_u32 v86, v118 offset:34368
ds_add_u32 v86, v119 offset:36928
ds_add_rtn_u32 v73, v86, v76 offset:26688
acc_sb_10:
s_mov_b64 exec, s[68:69]
s_cbranch_execz acc_sb_11
v_lshrrev_b32 v122, 21, v52
v_and_b32 v120, v72, v52
v_lshl_or_b32 v121, v54, 16, v122
buffer_load_dwordx2 v[124:125], v120, s[28:31], 0 offen
v_lshlrev_b32_sdwa v106, 4, v121 dst_sel:DWORD dst_unused:UNUSED_PAD src0_sel:DWORD src1_sel:WORD_0
v_lshlrev_b32_sdwa v104, 3, v121 dst_sel:DWORD dst_unused:UNUSED_PAD src0_sel:DWORD src1_sel:WORD_0
ds_read_b128 v[80:83], v106 offset:0
ds_read_b64 v[84:85], v104 offset:10240
v_lshlrev_b32_sdwa v86, 2, v121 dst_sel:DWORD dst_unused:UNUSED_PAD src0_sel:DWORD src1_sel:WORD_0
v_and_b32 v107, v21, v121
v_mul_f32 v108, v22, v107
v_mul_f32 v109, v23, v107
v_mul_f32 v110, v24, v107
v_fract_f32 v108, v108
v_fract_f32 v109, v109
v_fract_f32 v110, v110
v_cos_f32 v108, v108
v_cos_f32 v109, v109
v_cos_f32 v110, v110
s_waitcnt vmcnt(0)
v_lshlrev_b32 v112, 16, v124
v_and_b32 v113, v21, v124
v_mul_f32 v108, v26, v108
v_mul_f32 v109, v26, v109
v_mul_f32 v110, v26, v110
v_lshlrev_b32 v114, 16, v125
v_and_b32 v115, v21, v125
s_waitcnt lgkmcnt(0)
v_max_u32 v75, v75, v73
v_fma_mix_f32 v116, v108, v80, 0 op_sel:[0,0,0] op_sel_hi:[0,1,0]
v_fma_mix_f32 v117, v108, v80, 0 op_sel:[0,1,0] op_sel_hi:[0,1,0]
v_fma_mix_f32 v118, v108, v81, 0 op_sel:[0,0,0] op_sel_hi:[0,1,0]
v_fma_mix_f32 v119, v108, v81, 0 op_sel:[0,1,0] op_sel_hi:[0,1,0]
v_fma_mix_f32 v116, v109, v82, v116 op_sel:[0,0,0] op_sel_hi:[0,1,0]
v_fma_mix_f32 v117, v109, v82, v117 op_sel:[0,1,0] op_sel_hi:[0,1,0]
v_fma_mix_f32 v118, v109, v83, v118 op_sel:[0,0,0] op_sel_hi:[0,1,0]
v_fma_mix_f32 v119, v109, v83, v119 op_sel:[0,1,0] op_sel_hi:[0,1,0]
v_fma_mix_f32 v116, v110, v84, v116 op_sel:[0,0,0] op_sel_hi:[0,1,0]
v_fma_mix_f32 v117, v110, v84, v117 op_sel:[0,1,0] op_sel_hi:[0,1,0]
v_fma_mix_f32 v118, v110, v85, v118 op_sel:[0,0,0] op_sel_hi:[0,1,0]
v_fma_mix_f32 v119, v110, v85, v119 op_sel:[0,1,0] op_sel_hi:[0,1,0]
v_pk_mul_f32 v[116:117], v[116:117], v[112:113]
v_pk_mul_f32 v[118:119], v[118:119], v[114:115]
v_cvt_rpi_i32_f32 v116, v116
v_cvt_rpi_i32_f32 v117, v117
v_cvt_rpi_i32_f32 v118, v118
v_cvt_rpi_i32_f32 v119, v119
ds_add_u32 v86, v116 offset:29248
ds_add_u32 v86, v117 offset:31808
ds_add_u32 v86, v118 offset:34368
ds_add_u32 v86, v119 offset:36928
ds_add_rtn_u32 v73, v86, v76 offset:26688
acc_sb_11:
s_mov_b64 exec, s[70:71]
s_cbranch_execz acc_sb_12
v_lshrrev_b32 v122, 21, v53
v_and_b32 v120, v72, v53
v_and_or_b32 v121, v54, v21, v122
buffer_load_dwordx2 v[124:125], v120, s[28:31], 0 offen
v_lshlrev_b32_sdwa v106, 4, v121 dst_sel:DWORD dst_unused:UNUSED_PAD src0_sel:DWORD src1_sel:WORD_0
v_lshlrev_b32_sdwa v104, 3, v121 dst_sel:DWORD dst_unused:UNUSED_PAD src0_sel:DWORD src1_sel:WORD_0
ds_read_b128 v[80:83], v106 offset:0
ds_read_b64 v[84:85], v104 offset:10240
v_lshlrev_b32_sdwa v86, 2, v121 dst_sel:DWORD dst_unused:UNUSED_PAD src0_sel:DWORD src1_sel:WORD_0
v_and_b32 v107, v21, v121
v_mul_f32 v108, v22, v107
v_mul_f32 v109, v23, v107
v_mul_f32 v110, v24, v107
v_fract_f32 v108, v108
v_fract_f32 v109, v109
v_fract_f32 v110, v110
v_cos_f32 v108, v108
v_cos_f32 v109, v109
v_cos_f32 v110, v110
s_waitcnt vmcnt(0)
v_lshlrev_b32 v112, 16, v124
v_and_b32 v113, v21, v124
v_mul_f32 v108, v26, v108
v_mul_f32 v109, v26, v109
v_mul_f32 v110, v26, v110
v_lshlrev_b32 v114, 16, v125
v_and_b32 v115, v21, v125
s_waitcnt lgkmcnt(0)
v_max_u32 v75, v75, v73
v_fma_mix_f32 v116, v108, v80, 0 op_sel:[0,0,0] op_sel_hi:[0,1,0]
v_fma_mix_f32 v117, v108, v80, 0 op_sel:[0,1,0] op_sel_hi:[0,1,0]
v_fma_mix_f32 v118, v108, v81, 0 op_sel:[0,0,0] op_sel_hi:[0,1,0]
v_fma_mix_f32 v119, v108, v81, 0 op_sel:[0,1,0] op_sel_hi:[0,1,0]
v_fma_mix_f32 v116, v109, v82, v116 op_sel:[0,0,0] op_sel_hi:[0,1,0]
v_fma_mix_f32 v117, v109, v82, v117 op_sel:[0,1,0] op_sel_hi:[0,1,0]
v_fma_mix_f32 v118, v109, v83, v118 op_sel:[0,0,0] op_sel_hi:[0,1,0]
v_fma_mix_f32 v119, v109, v83, v119 op_sel:[0,1,0] op_sel_hi:[0,1,0]
v_fma_mix_f32 v116, v110, v84, v116 op_sel:[0,0,0] op_sel_hi:[0,1,0]
v_fma_mix_f32 v117, v110, v84, v117 op_sel:[0,1,0] op_sel_hi:[0,1,0]
v_fma_mix_f32 v118, v110, v85, v118 op_sel:[0,0,0] op_sel_hi:[0,1,0]
v_fma_mix_f32 v119, v110, v85, v119 op_sel:[0,1,0] op_sel_hi:[0,1,0]
v_pk_mul_f32 v[116:117], v[116:117], v[112:113]
v_pk_mul_f32 v[118:119], v[118:119], v[114:115]
v_cvt_rpi_i32_f32 v116, v116
v_cvt_rpi_i32_f32 v117, v117
v_cvt_rpi_i32_f32 v118, v118
v_cvt_rpi_i32_f32 v119, v119
ds_add_u32 v86, v116 offset:29248
ds_add_u32 v86, v117 offset:31808
ds_add_u32 v86, v118 offset:34368
ds_add_u32 v86, v119 offset:36928
ds_add_rtn_u32 v73, v86, v76 offset:26688
acc_sb_12:
s_mov_b64 exec, s[72:73]
s_cbranch_execz acc_sb_13
v_lshrrev_b32 v122, 21, v56
v_and_b32 v120, v72, v56
v_lshl_or_b32 v121, v58, 16, v122
buffer_load_dwordx2 v[124:125], v120, s[28:31], 0 offen
v_lshlrev_b32_sdwa v106, 4, v121 dst_sel:DWORD dst_unused:UNUSED_PAD src0_sel:DWORD src1_sel:WORD_0
v_lshlrev_b32_sdwa v104, 3, v121 dst_sel:DWORD dst_unused:UNUSED_PAD src0_sel:DWORD src1_sel:WORD_0
ds_read_b128 v[80:83], v106 offset:0
ds_read_b64 v[84:85], v104 offset:10240
v_lshlrev_b32_sdwa v86, 2, v121 dst_sel:DWORD dst_unused:UNUSED_PAD src0_sel:DWORD src1_sel:WORD_0
v_and_b32 v107, v21, v121
v_mul_f32 v108, v22, v107
v_mul_f32 v109, v23, v107
v_mul_f32 v110, v24, v107
v_fract_f32 v108, v108
v_fract_f32 v109, v109
v_fract_f32 v110, v110
v_cos_f32 v108, v108
v_cos_f32 v109, v109
v_cos_f32 v110, v110
s_waitcnt vmcnt(0)
v_lshlrev_b32 v112, 16, v124
v_and_b32 v113, v21, v124
v_mul_f32 v108, v26, v108
v_mul_f32 v109, v26, v109
v_mul_f32 v110, v26, v110
v_lshlrev_b32 v114, 16, v125
v_and_b32 v115, v21, v125
s_waitcnt lgkmcnt(0)
v_max_u32 v75, v75, v73
v_fma_mix_f32 v116, v108, v80, 0 op_sel:[0,0,0] op_sel_hi:[0,1,0]
v_fma_mix_f32 v117, v108, v80, 0 op_sel:[0,1,0] op_sel_hi:[0,1,0]
v_fma_mix_f32 v118, v108, v81, 0 op_sel:[0,0,0] op_sel_hi:[0,1,0]
v_fma_mix_f32 v119, v108, v81, 0 op_sel:[0,1,0] op_sel_hi:[0,1,0]
v_fma_mix_f32 v116, v109, v82, v116 op_sel:[0,0,0] op_sel_hi:[0,1,0]
v_fma_mix_f32 v117, v109, v82, v117 op_sel:[0,1,0] op_sel_hi:[0,1,0]
v_fma_mix_f32 v118, v109, v83, v118 op_sel:[0,0,0] op_sel_hi:[0,1,0]
v_fma_mix_f32 v119, v109, v83, v119 op_sel:[0,1,0] op_sel_hi:[0,1,0]
v_fma_mix_f32 v116, v110, v84, v116 op_sel:[0,0,0] op_sel_hi:[0,1,0]
v_fma_mix_f32 v117, v110, v84, v117 op_sel:[0,1,0] op_sel_hi:[0,1,0]
v_fma_mix_f32 v118, v110, v85, v118 op_sel:[0,0,0] op_sel_hi:[0,1,0]
v_fma_mix_f32 v119, v110, v85, v119 op_sel:[0,1,0] op_sel_hi:[0,1,0]
v_pk_mul_f32 v[116:117], v[116:117], v[112:113]
v_pk_mul_f32 v[118:119], v[118:119], v[114:115]
v_cvt_rpi_i32_f32 v116, v116
v_cvt_rpi_i32_f32 v117, v117
v_cvt_rpi_i32_f32 v118, v118
v_cvt_rpi_i32_f32 v119, v119
ds_add_u32 v86, v116 offset:29248
ds_add_u32 v86, v117 offset:31808
ds_add_u32 v86, v118 offset:34368
ds_add_u32 v86, v119 offset:36928
ds_add_rtn_u32 v73, v86, v76 offset:26688
acc_sb_13:
s_mov_b64 exec, s[74:75]
s_cbranch_execz acc_sb_14
v_lshrrev_b32 v122, 21, v57
v_and_b32 v120, v72, v57
v_and_or_b32 v121, v58, v21, v122
buffer_load_dwordx2 v[124:125], v120, s[28:31], 0 offen
v_lshlrev_b32_sdwa v106, 4, v121 dst_sel:DWORD dst_unused:UNUSED_PAD src0_sel:DWORD src1_sel:WORD_0
v_lshlrev_b32_sdwa v104, 3, v121 dst_sel:DWORD dst_unused:UNUSED_PAD src0_sel:DWORD src1_sel:WORD_0
ds_read_b128 v[80:83], v106 offset:0
ds_read_b64 v[84:85], v104 offset:10240
v_lshlrev_b32_sdwa v86, 2, v121 dst_sel:DWORD dst_unused:UNUSED_PAD src0_sel:DWORD src1_sel:WORD_0
v_and_b32 v107, v21, v121
v_mul_f32 v108, v22, v107
v_mul_f32 v109, v23, v107
v_mul_f32 v110, v24, v107
v_fract_f32 v108, v108
v_fract_f32 v109, v109
v_fract_f32 v110, v110
v_cos_f32 v108, v108
v_cos_f32 v109, v109
v_cos_f32 v110, v110
s_waitcnt vmcnt(0)
v_lshlrev_b32 v112, 16, v124
v_and_b32 v113, v21, v124
v_mul_f32 v108, v26, v108
v_mul_f32 v109, v26, v109
v_mul_f32 v110, v26, v110
v_lshlrev_b32 v114, 16, v125
v_and_b32 v115, v21, v125
s_waitcnt lgkmcnt(0)
v_max_u32 v75, v75, v73
v_fma_mix_f32 v116, v108, v80, 0 op_sel:[0,0,0] op_sel_hi:[0,1,0]
v_fma_mix_f32 v117, v108, v80, 0 op_sel:[0,1,0] op_sel_hi:[0,1,0]
v_fma_mix_f32 v118, v108, v81, 0 op_sel:[0,0,0] op_sel_hi:[0,1,0]
v_fma_mix_f32 v119, v108, v81, 0 op_sel:[0,1,0] op_sel_hi:[0,1,0]
v_fma_mix_f32 v116, v109, v82, v116 op_sel:[0,0,0] op_sel_hi:[0,1,0]
v_fma_mix_f32 v117, v109, v82, v117 op_sel:[0,1,0] op_sel_hi:[0,1,0]
v_fma_mix_f32 v118, v109, v83, v118 op_sel:[0,0,0] op_sel_hi:[0,1,0]
v_fma_mix_f32 v119, v109, v83, v119 op_sel:[0,1,0] op_sel_hi:[0,1,0]
v_fma_mix_f32 v116, v110, v84, v116 op_sel:[0,0,0] op_sel_hi:[0,1,0]
v_fma_mix_f32 v117, v110, v84, v117 op_sel:[0,1,0] op_sel_hi:[0,1,0]
v_fma_mix_f32 v118, v110, v85, v118 op_sel:[0,0,0] op_sel_hi:[0,1,0]
v_fma_mix_f32 v119, v110, v85, v119 op_sel:[0,1,0] op_sel_hi:[0,1,0]
v_pk_mul_f32 v[116:117], v[116:117], v[112:113]
v_pk_mul_f32 v[118:119], v[118:119], v[114:115]
v_cvt_rpi_i32_f32 v116, v116
v_cvt_rpi_i32_f32 v117, v117
v_cvt_rpi_i32_f32 v118, v118
v_cvt_rpi_i32_f32 v119, v119
ds_add_u32 v86, v116 offset:29248
ds_add_u32 v86, v117 offset:31808
ds_add_u32 v86, v118 offset:34368
ds_add_u32 v86, v119 offset:36928
ds_add_rtn_u32 v73, v86, v76 offset:26688
acc_sb_14:
s_mov_b64 exec, s[76:77]
s_cbranch_execz acc_sb_15
v_lshrrev_b32 v122, 21, v60
v_and_b32 v120, v72, v60
v_lshl_or_b32 v121, v62, 16, v122
buffer_load_dwordx2 v[124:125], v120, s[28:31], 0 offen
v_lshlrev_b32_sdwa v106, 4, v121 dst_sel:DWORD dst_unused:UNUSED_PAD src0_sel:DWORD src1_sel:WORD_0
v_lshlrev_b32_sdwa v104, 3, v121 dst_sel:DWORD dst_unused:UNUSED_PAD src0_sel:DWORD src1_sel:WORD_0
ds_read_b128 v[80:83], v106 offset:0
ds_read_b64 v[84:85], v104 offset:10240
v_lshlrev_b32_sdwa v86, 2, v121 dst_sel:DWORD dst_unused:UNUSED_PAD src0_sel:DWORD src1_sel:WORD_0
v_and_b32 v107, v21, v121
v_mul_f32 v108, v22, v107
v_mul_f32 v109, v23, v107
v_mul_f32 v110, v24, v107
v_fract_f32 v108, v108
v_fract_f32 v109, v109
v_fract_f32 v110, v110
v_cos_f32 v108, v108
v_cos_f32 v109, v109
v_cos_f32 v110, v110
s_waitcnt vmcnt(0)
v_lshlrev_b32 v112, 16, v124
v_and_b32 v113, v21, v124
v_mul_f32 v108, v26, v108
v_mul_f32 v109, v26, v109
v_mul_f32 v110, v26, v110
v_lshlrev_b32 v114, 16, v125
v_and_b32 v115, v21, v125
s_waitcnt lgkmcnt(0)
v_max_u32 v75, v75, v73
v_fma_mix_f32 v116, v108, v80, 0 op_sel:[0,0,0] op_sel_hi:[0,1,0]
v_fma_mix_f32 v117, v108, v80, 0 op_sel:[0,1,0] op_sel_hi:[0,1,0]
v_fma_mix_f32 v118, v108, v81, 0 op_sel:[0,0,0] op_sel_hi:[0,1,0]
v_fma_mix_f32 v119, v108, v81, 0 op_sel:[0,1,0] op_sel_hi:[0,1,0]
v_fma_mix_f32 v116, v109, v82, v116 op_sel:[0,0,0] op_sel_hi:[0,1,0]
v_fma_mix_f32 v117, v109, v82, v117 op_sel:[0,1,0] op_sel_hi:[0,1,0]
v_fma_mix_f32 v118, v109, v83, v118 op_sel:[0,0,0] op_sel_hi:[0,1,0]
v_fma_mix_f32 v119, v109, v83, v119 op_sel:[0,1,0] op_sel_hi:[0,1,0]
v_fma_mix_f32 v116, v110, v84, v116 op_sel:[0,0,0] op_sel_hi:[0,1,0]
v_fma_mix_f32 v117, v110, v84, v117 op_sel:[0,1,0] op_sel_hi:[0,1,0]
v_fma_mix_f32 v118, v110, v85, v118 op_sel:[0,0,0] op_sel_hi:[0,1,0]
v_fma_mix_f32 v119, v110, v85, v119 op_sel:[0,1,0] op_sel_hi:[0,1,0]
v_pk_mul_f32 v[116:117], v[116:117], v[112:113]
v_pk_mul_f32 v[118:119], v[118:119], v[114:115]
v_cvt_rpi_i32_f32 v116, v116
v_cvt_rpi_i32_f32 v117, v117
v_cvt_rpi_i32_f32 v118, v118
v_cvt_rpi_i32_f32 v119, v119
ds_add_u32 v86, v116 offset:29248
ds_add_u32 v86, v117 offset:31808
ds_add_u32 v86, v118 offset:34368
ds_add_u32 v86, v119 offset:36928
ds_add_rtn_u32 v73, v86, v76 offset:26688
acc_sb_15:
s_mov_b64 exec, s[78:79]
s_cbranch_execz acc_sb_16
v_lshrrev_b32 v122, 21, v61
v_and_b32 v120, v72, v61
v_and_or_b32 v121, v62, v21, v122
buffer_load_dwordx2 v[124:125], v120, s[28:31], 0 offen
v_lshlrev_b32_sdwa v106, 4, v121 dst_sel:DWORD dst_unused:UNUSED_PAD src0_sel:DWORD src1_sel:WORD_0
v_lshlrev_b32_sdwa v104, 3, v121 dst_sel:DWORD dst_unused:UNUSED_PAD src0_sel:DWORD src1_sel:WORD_0
ds_read_b128 v[80:83], v106 offset:0
ds_read_b64 v[84:85], v104 offset:10240
v_lshlrev_b32_sdwa v86, 2, v121 dst_sel:DWORD dst_unused:UNUSED_PAD src0_sel:DWORD src1_sel:WORD_0
v_and_b32 v107, v21, v121
v_mul_f32 v108, v22, v107
v_mul_f32 v109, v23, v107
v_mul_f32 v110, v24, v107
v_fract_f32 v108, v108
v_fract_f32 v109, v109
v_fract_f32 v110, v110
v_cos_f32 v108, v108
v_cos_f32 v109, v109
v_cos_f32 v110, v110
s_waitcnt vmcnt(0)
v_lshlrev_b32 v112, 16, v124
v_and_b32 v113, v21, v124
v_mul_f32 v108, v26, v108
v_mul_f32 v109, v26, v109
v_mul_f32 v110, v26, v110
v_lshlrev_b32 v114, 16, v125
v_and_b32 v115, v21, v125
s_waitcnt lgkmcnt(0)
v_max_u32 v75, v75, v73
v_fma_mix_f32 v116, v108, v80, 0 op_sel:[0,0,0] op_sel_hi:[0,1,0]
v_fma_mix_f32 v117, v108, v80, 0 op_sel:[0,1,0] op_sel_hi:[0,1,0]
v_fma_mix_f32 v118, v108, v81, 0 op_sel:[0,0,0] op_sel_hi:[0,1,0]
v_fma_mix_f32 v119, v108, v81, 0 op_sel:[0,1,0] op_sel_hi:[0,1,0]
v_fma_mix_f32 v116, v109, v82, v116 op_sel:[0,0,0] op_sel_hi:[0,1,0]
v_fma_mix_f32 v117, v109, v82, v117 op_sel:[0,1,0] op_sel_hi:[0,1,0]
v_fma_mix_f32 v118, v109, v83, v118 op_sel:[0,0,0] op_sel_hi:[0,1,0]
v_fma_mix_f32 v119, v109, v83, v119 op_sel:[0,1,0] op_sel_hi:[0,1,0]
v_fma_mix_f32 v116, v110, v84, v116 op_sel:[0,0,0] op_sel_hi:[0,1,0]
v_fma_mix_f32 v117, v110, v84, v117 op_sel:[0,1,0] op_sel_hi:[0,1,0]
v_fma_mix_f32 v118, v110, v85, v118 op_sel:[0,0,0] op_sel_hi:[0,1,0]
v_fma_mix_f32 v119, v110, v85, v119 op_sel:[0,1,0] op_sel_hi:[0,1,0]
v_pk_mul_f32 v[116:117], v[116:117], v[112:113]
v_pk_mul_f32 v[118:119], v[118:119], v[114:115]
v_cvt_rpi_i32_f32 v116, v116
v_cvt_rpi_i32_f32 v117, v117
v_cvt_rpi_i32_f32 v118, v118
v_cvt_rpi_i32_f32 v119, v119
ds_add_u32 v86, v116 offset:29248
ds_add_u32 v86, v117 offset:31808
ds_add_u32 v86, v118 offset:34368
ds_add_u32 v86, v119 offset:36928
ds_add_rtn_u32 v73, v86, v76 offset:26688
acc_sb_16:
s_mov_b64 exec, s[8:9]
s_cbranch_execz acc_sb_17
v_lshrrev_b32 v122, 21, v28
v_and_b32 v120, v72, v28
v_lshl_or_b32 v121, v30, 16, v122
buffer_load_dwordx2 v[124:125], v120, s[28:31], 0 offen
v_lshlrev_b32_sdwa v106, 4, v121 dst_sel:DWORD dst_unused:UNUSED_PAD src0_sel:DWORD src1_sel:WORD_0
v_lshlrev_b32_sdwa v104, 3, v121 dst_sel:DWORD dst_unused:UNUSED_PAD src0_sel:DWORD src1_sel:WORD_0
ds_read_b128 v[80:83], v106 offset:0
ds_read_b64 v[84:85], v104 offset:10240
v_lshlrev_b32_sdwa v86, 2, v121 dst_sel:DWORD dst_unused:UNUSED_PAD src0_sel:DWORD src1_sel:WORD_0
v_and_b32 v107, v21, v121
v_mul_f32 v108, v22, v107
v_mul_f32 v109, v23, v107
v_mul_f32 v110, v24, v107
v_fract_f32 v108, v108
v_fract_f32 v109, v109
v_fract_f32 v110, v110
v_cos_f32 v108, v108
v_cos_f32 v109, v109
v_cos_f32 v110, v110
s_waitcnt vmcnt(0)
v_lshlrev_b32 v112, 16, v124
v_and_b32 v113, v21, v124
v_mul_f32 v108, v26, v108
v_mul_f32 v109, v26, v109
v_mul_f32 v110, v26, v110
v_lshlrev_b32 v114, 16, v125
v_and_b32 v115, v21, v125
s_waitcnt lgkmcnt(0)
v_max_u32 v75, v75, v73
v_fma_mix_f32 v116, v108, v80, 0 op_sel:[0,0,0] op_sel_hi:[0,1,0]
v_fma_mix_f32 v117, v108, v80, 0 op_sel:[0,1,0] op_sel_hi:[0,1,0]
v_fma_mix_f32 v118, v108, v81, 0 op_sel:[0,0,0] op_sel_hi:[0,1,0]
v_fma_mix_f32 v119, v108, v81, 0 op_sel:[0,1,0] op_sel_hi:[0,1,0]
v_fma_mix_f32 v116, v109, v82, v116 op_sel:[0,0,0] op_sel_hi:[0,1,0]
v_fma_mix_f32 v117, v109, v82, v117 op_sel:[0,1,0] op_sel_hi:[0,1,0]
v_fma_mix_f32 v118, v109, v83, v118 op_sel:[0,0,0] op_sel_hi:[0,1,0]
v_fma_mix_f32 v119, v109, v83, v119 op_sel:[0,1,0] op_sel_hi:[0,1,0]
v_fma_mix_f32 v116, v110, v84, v116 op_sel:[0,0,0] op_sel_hi:[0,1,0]
v_fma_mix_f32 v117, v110, v84, v117 op_sel:[0,1,0] op_sel_hi:[0,1,0]
v_fma_mix_f32 v118, v110, v85, v118 op_sel:[0,0,0] op_sel_hi:[0,1,0]
v_fma_mix_f32 v119, v110, v85, v119 op_sel:[0,1,0] op_sel_hi:[0,1,0]
v_pk_mul_f32 v[116:117], v[116:117], v[112:113]
v_pk_mul_f32 v[118:119], v[118:119], v[114:115]
v_cvt_rpi_i32_f32 v116, v116
v_cvt_rpi_i32_f32 v117, v117
v_cvt_rpi_i32_f32 v118, v118
v_cvt_rpi_i32_f32 v119, v119
ds_add_u32 v86, v116 offset:29248
ds_add_u32 v86, v117 offset:31808
ds_add_u32 v86, v118 offset:34368
ds_add_u32 v86, v119 offset:36928
ds_add_rtn_u32 v73, v86, v76 offset:26688
acc_sb_17:
s_mov_b64 exec, s[40:41]
s_cbranch_execz acc_sb_18
v_lshrrev_b32 v122, 21, v29
v_and_b32 v120, v72, v29
v_and_or_b32 v121, v30, v21, v122
buffer_load_dwordx2 v[124:125], v120, s[28:31], 0 offen
v_lshlrev_b32_sdwa v106, 4, v121 dst_sel:DWORD dst_unused:UNUSED_PAD src0_sel:DWORD src1_sel:WORD_0
v_lshlrev_b32_sdwa v104, 3, v121 dst_sel:DWORD dst_unused:UNUSED_PAD src0_sel:DWORD src1_sel:WORD_0
ds_read_b128 v[80:83], v106 offset:0
ds_read_b64 v[84:85], v104 offset:10240
v_lshlrev_b32_sdwa v86, 2, v121 dst_sel:DWORD dst_unused:UNUSED_PAD src0_sel:DWORD src1_sel:WORD_0
v_and_b32 v107, v21, v121
v_mul_f32 v108, v22, v107
v_mul_f32 v109, v23, v107
v_mul_f32 v110, v24, v107
v_fract_f32 v108, v108
v_fract_f32 v109, v109
v_fract_f32 v110, v110
v_cos_f32 v108, v108
v_cos_f32 v109, v109
v_cos_f32 v110, v110
s_waitcnt vmcnt(0)
v_lshlrev_b32 v112, 16, v124
v_and_b32 v113, v21, v124
v_mul_f32 v108, v26, v108
v_mul_f32 v109, v26, v109
v_mul_f32 v110, v26, v110
v_lshlrev_b32 v114, 16, v125
v_and_b32 v115, v21, v125
s_waitcnt lgkmcnt(0)
v_max_u32 v75, v75, v73
v_fma_mix_f32 v116, v108, v80, 0 op_sel:[0,0,0] op_sel_hi:[0,1,0]
v_fma_mix_f32 v117, v108, v80, 0 op_sel:[0,1,0] op_sel_hi:[0,1,0]
v_fma_mix_f32 v118, v108, v81, 0 op_sel:[0,0,0] op_sel_hi:[0,1,0]
v_fma_mix_f32 v119, v108, v81, 0 op_sel:[0,1,0] op_sel_hi:[0,1,0]
v_fma_mix_f32 v116, v109, v82, v116 op_sel:[0,0,0] op_sel_hi:[0,1,0]
v_fma_mix_f32 v117, v109, v82, v117 op_sel:[0,1,0] op_sel_hi:[0,1,0]
v_fma_mix_f32 v118, v109, v83, v118 op_sel:[0,0,0] op_sel_hi:[0,1,0]
v_fma_mix_f32 v119, v109, v83, v119 op_sel:[0,1,0] op_sel_hi:[0,1,0]
v_fma_mix_f32 v116, v110, v84, v116 op_sel:[0,0,0] op_sel_hi:[0,1,0]
v_fma_mix_f32 v117, v110, v84, v117 op_sel:[0,1,0] op_sel_hi:[0,1,0]
v_fma_mix_f32 v118, v110, v85, v118 op_sel:[0,0,0] op_sel_hi:[0,1,0]
v_fma_mix_f32 v119, v110, v85, v119 op_sel:[0,1,0] op_sel_hi:[0,1,0]
v_pk_mul_f32 v[116:117], v[116:117], v[112:113]
v_pk_mul_f32 v[118:119], v[118:119], v[114:115]
v_cvt_rpi_i32_f32 v116, v116
v_cvt_rpi_i32_f32 v117, v117
v_cvt_rpi_i32_f32 v118, v118
v_cvt_rpi_i32_f32 v119, v119
ds_add_u32 v86, v116 offset:29248
ds_add_u32 v86, v117 offset:31808
ds_add_u32 v86, v118 offset:34368
ds_add_u32 v86, v119 offset:36928
ds_add_rtn_u32 v73, v86, v76 offset:26688
acc_sb_18:
s_mov_b64 exec, -1
s_branch acc_wide_back
acc_xsetup_g:
s_mov_b32 s11, 0
s_mov_b32 s16, 16
s_mov_b32 s17, 0
v_readlane_b32 s96, v119, 32
s_nop 0
s_cmp_gt_u32 s96, 4128767
s_cselect_b32 s16, 15, s16
s_cselect_b32 s17, s96, s17
s_addc_u32 s11, s11, 0
v_readlane_b32 s96, v118, 32
s_nop 0
s_cmp_gt_u32 s96, 4128767
s_cselect_b32 s16, 14, s16
s_cselect_b32 s17, s96, s17
s_addc_u32 s11, s11, 0
v_readlane_b32 s96, v117, 32
s_nop 0
s_cmp_gt_u32 s96, 4128767
s_cselect_b32 s16, 13, s16
s_cselect_b32 s17, s96, s17
s_addc_u32 s11, s11, 0
v_readlane_b32 s96, v116, 32
s_nop 0
s_cmp_gt_u32 s96, 4128767
s_cselect_b32 s16, 12, s16
s_cselect_b32 s17, s96, s17
s_addc_u32 s11, s11, 0
v_readlane_b32 s96, v115, 32
s_nop 0
s_cmp_gt_u32 s96, 4128767
s_cselect_b32 s16, 11, s16
s_cselect_b32 s17, s96, s17
s_addc_u32 s11, s11, 0
v_readlane_b32 s96, v114, 32
s_nop 0
s_cmp_gt_u32 s96, 4128767
s_cselect_b32 s16, 10, s16
s_cselect_b32 s17, s96, s17
s_addc_u32 s11, s11, 0
v_readlane_b32 s96, v113, 32
s_nop 0
s_cmp_gt_u32 s96, 4128767
s_cselect_b32 s16, 9, s16
s_cselect_b32 s17, s96, s17
s_addc_u32 s11, s11, 0
v_readlane_b32 s96, v112, 32
s_nop 0
s_cmp_gt_u32 s96, 4128767
s_cselect_b32 s16, 8, s16
s_cselect_b32 s17, s96, s17
s_addc_u32 s11, s11, 0
v_readlane_b32 s96, v119, 0
s_nop 0
s_cmp_gt_u32 s96, 4128767
s_cselect_b32 s16, 7, s16
s_cselect_b32 s17, s96, s17
s_addc_u32 s11, s11, 0
v_readlane_b32 s96, v118, 0
s_nop 0
s_cmp_gt_u32 s96, 4128767
s_cselect_b32 s16, 6, s16
s_cselect_b32 s17, s96, s17
s_addc_u32 s11, s11, 0
v_readlane_b32 s96, v117, 0
s_nop 0
s_cmp_gt_u32 s96, 4128767
s_cselect_b32 s16, 5, s16
s_cselect_b32 s17, s96, s17
s_addc_u32 s11, s11, 0
v_readlane_b32 s96, v116, 0
s_nop 0
s_cmp_gt_u32 s96, 4128767
s_cselect_b32 s16, 4, s16
s_cselect_b32 s17, s96, s17
s_addc_u32 s11, s11, 0
v_readlane_b32 s96, v115, 0
s_nop 0
s_cmp_gt_u32 s96, 4128767
s_cselect_b32 s16, 3, s16
s_cselect_b32 s17, s96, s17
s_addc_u32 s11, s11, 0
v_readlane_b32 s96, v114, 0
s_nop 0
s_cmp_gt_u32 s96, 4128767
s_cselect_b32 s16, 2, s16
s_cselect_b32 s17, s96, s17
s_addc_u32 s11, s11, 0
v_readlane_b32 s96, v113, 0
s_nop 0
s_cmp_gt_u32 s96, 4128767
s_cselect_b32 s16, 1, s16
s_cselect_b32 s17, s96, s17
s_addc_u32 s11, s11, 0
v_readlane_b32 s96, v112, 0
s_nop 0
s_cmp_gt_u32 s96, 4128767
s_cselect_b32 s16, 0, s16
s_cselect_b32 s17, s96, s17
s_addc_u32 s11, s11, 0
s_lshl_b32 s96, s22, 4
s_add_u32 s96, s96, s16
s_mul_i32 s96, s96, 61568
s_and_b32 s98, s17, 0xffff
s_add_u32 s98, s98, s96
s_add_u32 s98, s98, 372
s_lshr_b32 s17, s17, 16
s_sub_u32 s17, s17, 62
s_sub_u32 s11, s11, 1
s_cmp_gt_u32 s17, 128
s_addc_u32 s11, s11, 0
s_min_u32 s17, s17, 128
v_lshlrev_b32 v9, 1, v1
v_add_u32 v10, 1, v9
v_cmp_gt_u32 s[8:9], s17, v9
v_cmp_gt_u32 s[40:41], s17, v10
v_mul_u32_u24 v9, 12, v1
s_mov_b32 s10, 1
s_nop 1
s_mov_b64 exec, s[8:9]
buffer_load_dwordx3 v[28:30], v9, s[24:27], s98 offen
s_mov_b64 exec, -1
s_branch acc_nox_g
acc_xsetup_n:
s_mov_b32 s11, 0
s_mov_b32 s16, 16
s_mov_b32 s17, 0
v_readlane_b32 s96, v119, 32
s_nop 0
s_cmp_gt_u32 s96, 4128767
s_cselect_b32 s16, 15, s16
s_cselect_b32 s17, s96, s17
s_addc_u32 s11, s11, 0
v_readlane_b32 s96, v118, 32
s_nop 0
s_cmp_gt_u32 s96, 4128767
s_cselect_b32 s16, 14, s16
s_cselect_b32 s17, s96, s17
s_addc_u32 s11, s11, 0
v_readlane_b32 s96, v117, 32
s_nop 0
s_cmp_gt_u32 s96, 4128767
s_cselect_b32 s16, 13, s16
s_cselect_b32 s17, s96, s17
s_addc_u32 s11, s11, 0
v_readlane_b32 s96, v116, 32
s_nop 0
s_cmp_gt_u32 s96, 4128767
s_cselect_b32 s16, 12, s16
s_cselect_b32 s17, s96, s17
s_addc_u32 s11, s11, 0
v_readlane_b32 s96, v115, 32
s_nop 0
s_cmp_gt_u32 s96, 4128767
s_cselect_b32 s16, 11, s16
s_cselect_b32 s17, s96, s17
s_addc_u32 s11, s11, 0
v_readlane_b32 s96, v114, 32
s_nop 0
s_cmp_gt_u32 s96, 4128767
s_cselect_b32 s16, 10, s16
s_cselect_b32 s17, s96, s17
s_addc_u32 s11, s11, 0
v_readlane_b32 s96, v113, 32
s_nop 0
s_cmp_gt_u32 s96, 4128767
s_cselect_b32 s16, 9, s16
s_cselect_b32 s17, s96, s17
s_addc_u32 s11, s11, 0
v_readlane_b32 s96, v112, 32
s_nop 0
s_cmp_gt_u32 s96, 4128767
s_cselect_b32 s16, 8, s16
s_cselect_b32 s17, s96, s17
s_addc_u32 s11, s11, 0
v_readlane_b32 s96, v119, 0
s_nop 0
s_cmp_gt_u32 s96, 4128767
s_cselect_b32 s16, 7, s16
s_cselect_b32 s17, s96, s17
s_addc_u32 s11, s11, 0
v_readlane_b32 s96, v118, 0
s_nop 0
s_cmp_gt_u32 s96, 4128767
s_cselect_b32 s16, 6, s16
s_cselect_b32 s17, s96, s17
s_addc_u32 s11, s11, 0
v_readlane_b32 s96, v117, 0
s_nop 0
s_cmp_gt_u32 s96, 4128767
s_cselect_b32 s16, 5, s16
s_cselect_b32 s17, s96, s17
s_addc_u32 s11, s11, 0
v_readlane_b32 s96, v116, 0
s_nop 0
s_cmp_gt_u32 s96, 4128767
s_cselect_b32 s16, 4, s16
s_cselect_b32 s17, s96, s17
s_addc_u32 s11, s11, 0
v_readlane_b32 s96, v115, 0
s_nop 0
s_cmp_gt_u32 s96, 4128767
s_cselect_b32 s16, 3, s16
s_cselect_b32 s17, s96, s17
s_addc_u32 s11, s11, 0
v_readlane_b32 s96, v114, 0
s_nop 0
s_cmp_gt_u32 s96, 4128767
s_cselect_b32 s16, 2, s16
s_cselect_b32 s17, s96, s17
s_addc_u32 s11, s11, 0
v_readlane_b32 s96, v113, 0
s_nop 0
s_cmp_gt_u32 s96, 4128767
s_cselect_b32 s16, 1, s16
s_cselect_b32 s17, s96, s17
s_addc_u32 s11, s11, 0
v_readlane_b32 s96, v112, 0
s_nop 0
s_cmp_gt_u32 s96, 4128767
s_cselect_b32 s16, 0, s16
s_cselect_b32 s17, s96, s17
s_addc_u32 s11, s11, 0
s_lshl_b32 s96, s22, 4
s_add_u32 s96, s96, s16
s_mul_i32 s96, s96, 61568
s_and_b32 s98, s17, 0xffff
s_add_u32 s98, s98, s96
s_add_u32 s98, s98, 372
s_lshr_b32 s17, s17, 16
s_sub_u32 s17, s17, 62
s_sub_u32 s11, s11, 1
s_cmp_gt_u32 s17, 128
s_addc_u32 s11, s11, 0
s_min_u32 s17, s17, 128
v_lshlrev_b32 v9, 1, v1
v_add_u32 v10, 1, v9
v_cmp_gt_u32 s[8:9], s17, v9
v_cmp_gt_u32 s[40:41], s17, v10
v_mul_u32_u24 v9, 12, v1
s_mov_b32 s10, 1
s_nop 1
s_mov_b64 exec, s[8:9]
buffer_load_dwordx3 v[28:30], v9, s[24:27], s98 offen
s_mov_b64 exec, -1
s_branch acc_nox_n
acc_extra:
s_waitcnt vmcnt(0) lgkmcnt(0)
v_mul_u32_u24 v9, 12, v1
v_lshlrev_b32 v14, 1, v1
v_add_u32 v15, 1, v14
s_mov_b32 s36, 0
acc_extra_seg:
s_lshl_b32 s37, s22, 4
s_add_u32 s37, s37, s36
s_lshl_b32 s38, s37, 2
s_load_dword s96, s[32:33], s38
s_waitcnt lgkmcnt(0)
s_and_b32 s97, s96, 0xffff
s_lshr_b32 s96, s96, 16
s_min_u32 s38, s96, 62
s_sub_u32 s96, s96, s38
s_cmp_eq_u32 s36, s16
s_cselect_b32 s38, s17, 0
s_sub_u32 s96, s96, s38
s_add_u32 s38, s38, 62
s_mul_i32 s38, s38, 6
s_add_u32 s97, s97, s38
s_mul_i32 s37, s37, 61568
s_add_u32 s97, s97, s37
acc_extra_piece:
s_cmp_eq_u32 s96, 0
s_cbranch_scc1 acc_extra_next
s_min_u32 s98, s96, 128
v_cmp_gt_u32 s[8:9], s98, v14
v_cmp_gt_u32 s[40:41], s98, v15
s_nop 1
s_mov_b64 exec, s[8:9]
buffer_load_dwordx3 v[60:62], v9, s[24:27], s97 offen
s_waitcnt vmcnt(0)
s_mov_b64 exec, s[8:9]
s_cbranch_execz acc_sb_19
v_lshrrev_b32 v122, 21, v60
v_and_b32 v120, v72, v60
v_lshl_or_b32 v121, v62, 16, v122
buffer_load_dwordx2 v[124:125], v120, s[28:31], 0 offen
v_lshlrev_b32_sdwa v106, 4, v121 dst_sel:DWORD dst_unused:UNUSED_PAD src0_sel:DWORD src1_sel:WORD_0
v_lshlrev_b32_sdwa v104, 3, v121 dst_sel:DWORD dst_unused:UNUSED_PAD src0_sel:DWORD src1_sel:WORD_0
ds_read_b128 v[80:83], v106 offset:0
ds_read_b64 v[84:85], v104 offset:10240
v_lshlrev_b32_sdwa v86, 2, v121 dst_sel:DWORD dst_unused:UNUSED_PAD src0_sel:DWORD src1_sel:WORD_0
v_and_b32 v107, v21, v121
v_mul_f32 v108, v22, v107
v_mul_f32 v109, v23, v107
v_mul_f32 v110, v24, v107
v_fract_f32 v108, v108
v_fract_f32 v109, v109
v_fract_f32 v110, v110
v_cos_f32 v108, v108
v_cos_f32 v109, v109
v_cos_f32 v110, v110
s_waitcnt vmcnt(0)
v_lshlrev_b32 v112, 16, v124
v_and_b32 v113, v21, v124
v_mul_f32 v108, v26, v108
v_mul_f32 v109, v26, v109
v_mul_f32 v110, v26, v110
v_lshlrev_b32 v114, 16, v125
v_and_b32 v115, v21, v125
s_waitcnt lgkmcnt(0)
v_max_u32 v75, v75, v73
v_fma_mix_f32 v116, v108, v80, 0 op_sel:[0,0,0] op_sel_hi:[0,1,0]
v_fma_mix_f32 v117, v108, v80, 0 op_sel:[0,1,0] op_sel_hi:[0,1,0]
v_fma_mix_f32 v118, v108, v81, 0 op_sel:[0,0,0] op_sel_hi:[0,1,0]
v_fma_mix_f32 v119, v108, v81, 0 op_sel:[0,1,0] op_sel_hi:[0,1,0]
v_fma_mix_f32 v116, v109, v82, v116 op_sel:[0,0,0] op_sel_hi:[0,1,0]
v_fma_mix_f32 v117, v109, v82, v117 op_sel:[0,1,0] op_sel_hi:[0,1,0]
v_fma_mix_f32 v118, v109, v83, v118 op_sel:[0,0,0] op_sel_hi:[0,1,0]
v_fma_mix_f32 v119, v109, v83, v119 op_sel:[0,1,0] op_sel_hi:[0,1,0]
v_fma_mix_f32 v116, v110, v84, v116 op_sel:[0,0,0] op_sel_hi:[0,1,0]
v_fma_mix_f32 v117, v110, v84, v117 op_sel:[0,1,0] op_sel_hi:[0,1,0]
v_fma_mix_f32 v118, v110, v85, v118 op_sel:[0,0,0] op_sel_hi:[0,1,0]
v_fma_mix_f32 v119, v110, v85, v119 op_sel:[0,1,0] op_sel_hi:[0,1,0]
v_pk_mul_f32 v[116:117], v[116:117], v[112:113]
v_pk_mul_f32 v[118:119], v[118:119], v[114:115]
v_cvt_rpi_i32_f32 v116, v116
v_cvt_rpi_i32_f32 v117, v117
v_cvt_rpi_i32_f32 v118, v118
v_cvt_rpi_i32_f32 v119, v119
ds_add_u32 v86, v116 offset:29248
ds_add_u32 v86, v117 offset:31808
ds_add_u32 v86, v118 offset:34368
ds_add_u32 v86, v119 offset:36928
ds_add_rtn_u32 v73, v86, v76 offset:26688
acc_sb_19:
s_mov_b64 exec, s[40:41]
s_cbranch_execz acc_sb_20
v_lshrrev_b32 v122, 21, v61
v_and_b32 v120, v72, v61
v_and_or_b32 v121, v62, v21, v122
buffer_load_dwordx2 v[124:125], v120, s[28:31], 0 offen
v_lshlrev_b32_sdwa v106, 4, v121 dst_sel:DWORD dst_unused:UNUSED_PAD src0_sel:DWORD src1_sel:WORD_0
v_lshlrev_b32_sdwa v104, 3, v121 dst_sel:DWORD dst_unused:UNUSED_PAD src0_sel:DWORD src1_sel:WORD_0
ds_read_b128 v[80:83], v106 offset:0
ds_read_b64 v[84:85], v104 offset:10240
v_lshlrev_b32_sdwa v86, 2, v121 dst_sel:DWORD dst_unused:UNUSED_PAD src0_sel:DWORD src1_sel:WORD_0
v_and_b32 v107, v21, v121
v_mul_f32 v108, v22, v107
v_mul_f32 v109, v23, v107
v_mul_f32 v110, v24, v107
v_fract_f32 v108, v108
v_fract_f32 v109, v109
v_fract_f32 v110, v110
v_cos_f32 v108, v108
v_cos_f32 v109, v109
v_cos_f32 v110, v110
s_waitcnt vmcnt(0)
v_lshlrev_b32 v112, 16, v124
v_and_b32 v113, v21, v124
v_mul_f32 v108, v26, v108
v_mul_f32 v109, v26, v109
v_mul_f32 v110, v26, v110
v_lshlrev_b32 v114, 16, v125
v_and_b32 v115, v21, v125
s_waitcnt lgkmcnt(0)
v_max_u32 v75, v75, v73
v_fma_mix_f32 v116, v108, v80, 0 op_sel:[0,0,0] op_sel_hi:[0,1,0]
v_fma_mix_f32 v117, v108, v80, 0 op_sel:[0,1,0] op_sel_hi:[0,1,0]
v_fma_mix_f32 v118, v108, v81, 0 op_sel:[0,0,0] op_sel_hi:[0,1,0]
v_fma_mix_f32 v119, v108, v81, 0 op_sel:[0,1,0] op_sel_hi:[0,1,0]
v_fma_mix_f32 v116, v109, v82, v116 op_sel:[0,0,0] op_sel_hi:[0,1,0]
v_fma_mix_f32 v117, v109, v82, v117 op_sel:[0,1,0] op_sel_hi:[0,1,0]
v_fma_mix_f32 v118, v109, v83, v118 op_sel:[0,0,0] op_sel_hi:[0,1,0]
v_fma_mix_f32 v119, v109, v83, v119 op_sel:[0,1,0] op_sel_hi:[0,1,0]
v_fma_mix_f32 v116, v110, v84, v116 op_sel:[0,0,0] op_sel_hi:[0,1,0]
v_fma_mix_f32 v117, v110, v84, v117 op_sel:[0,1,0] op_sel_hi:[0,1,0]
v_fma_mix_f32 v118, v110, v85, v118 op_sel:[0,0,0] op_sel_hi:[0,1,0]
v_fma_mix_f32 v119, v110, v85, v119 op_sel:[0,1,0] op_sel_hi:[0,1,0]
v_pk_mul_f32 v[116:117], v[116:117], v[112:113]
v_pk_mul_f32 v[118:119], v[118:119], v[114:115]
v_cvt_rpi_i32_f32 v116, v116
v_cvt_rpi_i32_f32 v117, v117
v_cvt_rpi_i32_f32 v118, v118
v_cvt_rpi_i32_f32 v119, v119
ds_add_u32 v86, v116 offset:29248
ds_add_u32 v86, v117 offset:31808
ds_add_u32 v86, v118 offset:34368
ds_add_u32 v86, v119 offset:36928
ds_add_rtn_u32 v73, v86, v76 offset:26688
acc_sb_20:
s_waitcnt lgkmcnt(0)
s_mov_b64 exec, -1
s_sub_u32 s96, s96, s98
s_add_u32 s97, s97, 768
s_branch acc_extra_piece
acc_extra_next:
s_add_u32 s36, s36, 1
s_cmp_lt_u32 s36, 16
s_cbranch_scc1 acc_extra_seg
s_branch acc_x3
.section .rodata,"a"
.p2align 6
.amdhsa_kernel bin_kernel
  .amdhsa_next_free_vgpr 128
  .amdhsa_next_free_sgpr 102
  .amdhsa_accum_offset 128
  .amdhsa_group_segment_fixed_size 0
  .amdhsa_kernarg_size 112
  .amdhsa_user_sgpr_count 2
  .amdhsa_user_sgpr_kernarg_segment_ptr 1
  .amdhsa_system_sgpr_workgroup_id_x 1
  .amdhsa_float_denorm_mode_32 3
.end_amdhsa_kernel
.p2align 6
.amdhsa_kernel acc_kernel
  .amdhsa_next_free_vgpr 128
  .amdhsa_next_free_sgpr 102
  .amdhsa_accum_offset 128
  .amdhsa_group_segment_fixed_size 0
  .amdhsa_kernarg_size 112
  .amdhsa_user_sgpr_count 2
  .amdhsa_user_sgpr_kernarg_segment_ptr 1
  .amdhsa_system_sgpr_workgroup_id_x 1
  .amdhsa_float_denorm_mode_32 3
.end_amdhsa_kernel
```
